```python
import torch

def _softmax(x, axis=-1):
    return torch.softmax(x, dim=axis)
def _gelu(x):
    return torch.nn.functional.gelu(x, approximate="tanh")
def _silu(x):
    return torch.nn.functional.silu(x)
def _sigmoid(x):
    return torch.sigmoid(x)
def _layernorm(x, axis=-1, eps=1e-5):
    m = x.mean(dim=axis, keepdim=True)
    v = x.var(dim=axis, keepdim=True, unbiased=False)
    return (x - m) / torch.sqrt(v + eps)
def _scatter_add(tgt, idx, src, axis=0):
    return tgt.clone().index_add_(axis, idx, src)
def _segment_sum(src, seg, n):
    out = torch.zeros((n,) + src.shape[1:], dtype=src.dtype)
    return out.index_add_(0, seg, src)
def _pad(x, pw):
    flat = tuple(v for pair in reversed(pw) for v in pair)
    return torch.nn.functional.pad(x, flat)

kernel_name = 'parallel_sum__ssm_conv_s4d__geglu_ffn__prompt'

def setup_inputs():

    _w = (lambda a: (lambda t: t.to(torch.bfloat16) if t.is_floating_point() else t)(torch.as_tensor(a)))
    def _A_setup():
        Bsz, L, D, N = 1, 2048, 512, 128
        return {
            "u": _w((lambda *s: torch.randn(*s, dtype=torch.bfloat16) * 0.05)(Bsz, L, D)),
            "log_A_real": _w((lambda *s: torch.randn(*s, dtype=torch.bfloat16) * 3.2)(D, N) * 0.5),
            "A_imag": _w((lambda *s: torch.randn(*s, dtype=torch.bfloat16) * 0.1)(D, N) * 3.14),
            "C_real": _w((lambda *s: torch.randn(*s, dtype=torch.bfloat16) * 1.6)(D, N) / N ** 0.5),
            "C_imag": _w((lambda *s: torch.randn(*s, dtype=torch.bfloat16) * 1.6)(D, N) / N ** 0.5),
            "log_dt": _w((lambda *s: torch.randn(*s, dtype=torch.bfloat16) * 0.1)(D) * 0.5 - 4.0),
            "D_skip": _w((lambda *s: torch.randn(*s, dtype=torch.bfloat16) * 0.2)(D)),
        }
    _A_in = _A_setup()

    def _B_setup():
        B, S, D, F = 1, 2048, 512, 1376
        return {
            "x": _w((lambda *s: torch.randn(*s, dtype=torch.bfloat16) * 0.05)(B, S, D)),
            "w_gate": _w((lambda *s: torch.randn(*s, dtype=torch.bfloat16) * 0.05)(D, F)),
            "w_up": _w((lambda *s: torch.randn(*s, dtype=torch.bfloat16) * 0.05)(D, F)),
            "w_down": _w((lambda *s: torch.randn(*s, dtype=torch.bfloat16) * 0.05)(F, D)),
        }
    _B_in = _B_setup()

    return {
        "A_u": _A_in["u"],
        "A_log_A_real": _A_in["log_A_real"],
        "A_A_imag": _A_in["A_imag"],
        "A_C_real": _A_in["C_real"],
        "A_C_imag": _A_in["C_imag"],
        "A_log_dt": _A_in["log_dt"],
        "A_D_skip": _A_in["D_skip"],
        "B_x": _B_in["x"],
        "B_w_gate": _B_in["w_gate"],
        "B_w_up": _B_in["w_up"],
        "B_w_down": _B_in["w_down"],
    }

def reference(A_u, A_log_A_real, A_A_imag, A_C_real, A_C_imag, A_log_dt, A_D_skip, B_x, B_w_gate, B_w_up, B_w_down):
    def _A_ref(u, log_A_real, A_imag, C_real, C_imag, log_dt, D_skip):
        L = u.shape[1]
        dt = torch.exp(log_dt)
        A = -torch.exp(log_A_real) + 1j * A_imag
        C = (C_real + 1j * C_imag) * dt[:, None]
        pos = (lambda x, dt: x.to(dt))(torch.arange(L), log_dt.dtype)
        P = torch.exp((A * dt[:, None])[:, :, None] * pos[None, None, :])
        K = 2.0 * torch.einsum("dn,dnl->dl", C, P).real
        L2 = 2 * L
        u_t = (lambda x, *d: x.permute(*d))(u, 0, 2, 1)
        Kf = (lambda x, *a, **k: torch.fft.rfft(x.float(), *a, **k))(K, L2)
        Uf = (lambda x, *a, **k: torch.fft.rfft(x.float(), *a, **k))(u_t, L2)
        y = (lambda x, *a, **k: torch.fft.irfft(x, *a, **k).to(torch.bfloat16))(Uf * Kf[None, :, :], L2)[:, :, :L]
        y = (lambda x, *d: x.permute(*d))(y, 0, 2, 1)
        return y + u * D_skip[None, None, :]

    def _B_ref(x, w_gate, w_up, w_down):
        return (_gelu(x @ w_gate) * (x @ w_up)) @ w_down

    x = A_u
    xn = _layernorm(x, axis=-1)
    return x + _A_ref(xn, A_log_A_real, A_A_imag, A_C_real, A_C_imag, A_log_dt, A_D_skip) + _B_ref(xn, B_w_gate, B_w_up, B_w_down)
```

```asm
; @launch grid=(256,1,1) block=(512,1,1) lds=163840
.amdgcn_target "amdgcn-amd-amdhsa--gfx950"
.text
.globl parallel_sum__ssm_conv_s4d__geglu_ffn__prompt_kernel
.p2align 8
.type parallel_sum__ssm_conv_s4d__geglu_ffn__prompt_kernel,@function
parallel_sum__ssm_conv_s4d__geglu_ffn__prompt_kernel:
    s_cmp_ge_u32 s2, 256
    s_cbranch_scc1 L_end
    s_load_dwordx16 s[16:31], s[0:1], 0
    s_load_dwordx8 s[32:39], s[0:1], 64
    s_load_dwordx4 s[40:43], s[0:1], 96
    s_getpc_b64 s[62:63]
    s_lshr_b32 s5, s2, 3
    v_lshrrev_b32 v2, 3, v0
    s_and_b32 s61, s5, 3
    s_lshl_b32 s61, s61, 13
    v_lshl_add_u32 v2, v2, 7, s61
    global_load_dword v255, v2, s[62:63]
    v_lshrrev_b32 v2, 6, v0
    v_and_b32 v1, 63, v0
    v_readfirstlane_b32 s100, v2
    s_and_b32 s4, s2, 7
    s_and_b32 s61, s4, 3
    s_mul_i32 s62, s61, 28
    s_add_u32 s62, s62, s5
    s_and_b32 s63, s5, 2
    s_lshl_b32 s63, s63, 2
    s_lshl_b32 s61, s61, 1
    s_add_u32 s63, s63, s61
    s_and_b32 s61, s5, 1
    s_add_u32 s63, s63, s61
    s_add_u32 s63, s63, 112
    s_cmp_lt_u32 s5, 28
    s_cselect_b32 s62, s62, s63
    s_lshr_b32 s7, s62, 3
    s_and_b32 s6, s62, 7
    s_and_b32 s61, s4, 4
    s_lshl_b32 s61, s61, 1
    s_add_u32 s6, s6, s61
    s_and_b32 s3, s100, 3
    v_lshlrev_b32 v14, 4, v1
    v_lshrrev_b32 v17, 4, v1
    v_lshrrev_b32 v18, 3, v1
    s_mul_i32 s56, s3, 40960
    s_and_b32 s71, s3, 1
    s_lshr_b32 s86, s3, 1
    s_lshl_b32 s57, s4, 5
    s_add_u32 s57, s57, s5
    s_lshl_b32 s69, s57, 2
    s_add_u32 s69, s69, s3
    s_lshl_b32 s87, s6, 2
    s_add_u32 s87, s87, s3
    s_mul_i32 s68, s7, 192
    s_min_u32 s68, s68, 2560
    s_mov_b32 s11, 0x20000
    s_mov_b32 s10, 2097152
    s_mov_b32 s101, 0
    s_cmp_ge_u32 s100, 4
    s_cbranch_scc1 L_S
    s_lshl_b32 s70, s69, 11
    v_and_b32 v20, 7, v1
    v_and_b32 v21, 6, v18
    v_xor_b32 v21, v20, v21
    v_lshlrev_b32 v21, 4, v21
    v_lshl_add_u32 v224, v18, 10, v21
    v_add_u32 v225, 7168, v224
    s_lshl_b32 s72, s2, 1
    s_add_u32 s72, s72, s86
    s_lshr_b32 s73, s72, 3
    s_and_b32 s74, s72, 7
    s_lshl_b32 s75, s73, 15
    s_lshl_b32 s89, s74, 7
    s_add_u32 s75, s75, s89
    s_lshl_b32 s89, s71, 14
    s_add_u32 s75, s75, s89
    s_mul_i32 s88, s86, 81920
    s_add_u32 m0, s56, 34816
    s_mov_b32 s50, 1409024
    s_mov_b32 s51, 0x20000
    s_waitcnt lgkmcnt(0)
    s_mov_b32 s8, s16
    s_mov_b32 s9, s17
    s_mov_b32 s48, s36
    s_mov_b32 s49, s37
    buffer_load_dwordx4 v[192:195], v14, s[8:11], s70 offen
    buffer_load_dwordx4 v[196:199], v14, s[8:11], s70 offen offset:1024
    buffer_load_dwordx4 v224, s[48:51], s75 offen offset:0 lds
    buffer_load_dwordx4 v225, s[48:51], s75 offen offset:1024 lds
    s_load_dwordx2 s[58:59], s[42:43], 0
    s_mov_b32 s61, 1048576
    s_load_dword s64, s[42:43], s61
    s_mov_b32 s61, 2097152
    s_load_dword s65, s[42:43], s61
    s_mov_b32 s61, 12582912
    s_load_dword s66, s[42:43], s61
    s_setprio 1
    s_mov_b32 s44, s42
    s_mov_b32 s45, s43
    s_mov_b32 s46, 33554432
    s_mov_b32 s47, 0x20000
    s_mov_b32 s52, s38
    s_mov_b32 s53, s39
    s_mov_b32 s54, 2097152
    s_mov_b32 s55, 0x20000
    s_lshl_b32 s74, s74, 1
    s_add_u32 s74, s74, s71
    s_mul_i32 s89, s74, 86
    s_add_u32 s89, s89, s73
    s_lshl_b32 s89, s89, 10
    s_add_u32 s89, s89, 12582912
    s_cmp_lt_u32 s72, 344
    s_cselect_b32 s89, s89, 1073741824
    s_xor_b32 s61, s3, 1
    s_mul_i32 s60, s61, 40960
    v_and_b32 v16, 15, v1
    v_lshrrev_b32 v20, 1, v16
    v_xor_b32 v20, v20, v17
    v_lshlrev_b32 v20, 4, v20
    v_lshl_add_u32 v20, v16, 7, v20
    v_add_u32 v2, s56, v20
    v_xor_b32 v3, 64, v2
    v_add_u32 v4, s60, v20
    v_xor_b32 v5, 64, v4
    v_and_b32 v19, 3, v1
    v_lshlrev_b32 v19, 3, v19
    v_and_b32 v21, 1, v17
    v_bfe_u32 v20, v1, 2, 2
    v_lshl_add_u32 v20, v21, 3, v20
    v_mul_u32_u24 v20, 192, v20
    v_lshl_add_u32 v20, v21, 5, v20
    v_lshrrev_b32 v21, 1, v17
    v_mul_u32_u24 v21, 81920, v21
    v_add3_u32 v20, v20, v21, v19
    v_add_u32 v10, 4224, v20
    v_add_u32 v11, 40960, v10
    v_xor_b32 v12, 32, v10
    v_xor_b32 v13, 32, v11
    s_lshl_b32 s61, s71, 6
    s_sub_u32 s61, s61, 128
    v_add_u32 v6, s61, v10
    v_add_u32 v7, s61, v11
    v_add_u32 v8, s61, v12
    v_add_u32 v9, s61, v13
    s_lshl_b32 s61, s86, 5
    v_xor_b32 v226, s61, v20
    s_mul_i32 s61, s71, 40960
    s_add_u32 s61, s61, 4096
    v_add_u32 v226, s61, v226
    v_add_u32 v15, 44032, v14
    s_add_u32 s61, s56, 38912
    v_add_u32 v220, s61, v14
    v_mov_b32 v221, 0x3f803f80
    v_lshrrev_b32 v222, 5, v1
    v_lshlrev_b32 v222, 3, v222
    s_lshl_b32 s82, s69, 4
    s_add_u32 s82, s82, 196608
    s_add_u32 s83, s70, 1048576
    v_and_b32 v20, 1, v18
    v_mul_u32_u24 v227, 40960, v20
    v_bfe_u32 v20, v1, 2, 1
    v_lshlrev_b32 v20, 10, v20
    v_add3_u32 v227, v227, v20, v19
    v_lshl_add_u32 v227, v17, 5, v227
    s_lshl_b32 s61, s3, 8
    s_add_u32 s61, s61, 38912
    v_add_u32 v227, s61, v227
    v_add_u32 v228, 81920, v227
    v_lshrrev_b32 v21, 2, v1
    v_and_b32 v20, 6, v21
    v_lshlrev_b32 v20, 4, v20
    v_lshl_add_u32 v229, v21, 7, v20
    v_add3_u32 v229, v229, v19, s88
    v_add_u32 v229, 34816, v229
    s_lshl_b32 s61, s71, 6
    v_xor_b32 v229, s61, v229
    v_xor_b32 v230, 32, v229
    v_cmp_eq_u32 vcc, 0, v16
    s_nop 1
    v_cndmask_b32 v232, 0, v221, vcc
    v_mov_b32 v233, v232
    v_mov_b32 v234, v232
    v_mov_b32 v235, v232
    v_cmp_eq_u32 vcc, 1, v16
    s_nop 1
    v_cndmask_b32 v236, 0, v221, vcc
    v_mov_b32 v237, v236
    v_mov_b32 v238, v236
    v_mov_b32 v239, v236
    v_cmp_eq_u32 vcc, 2, v16
    s_nop 1
    v_cndmask_b32 v240, 0, v221, vcc
    v_mov_b32 v241, v240
    v_mov_b32 v242, v240
    v_mov_b32 v243, v240
    v_lshlrev_b32 v231, 8, v16
    v_lshl_add_u32 v231, v17, 4, v231
    s_lshl_b32 s96, s7, 4
    s_add_u32 s96, s96, s6
    s_mul_i32 s97, s96, 768
    s_lshl_b32 s61, s3, 6
    s_add_u32 s97, s97, s61
    s_add_u32 s97, s97, 262144
    s_waitcnt vmcnt(2)
    v_dot2_f32_bf16 v216, v192, v221, 0
    v_dot2_f32_bf16 v217, v196, v221, 0
    v_dot2_f32_bf16 v218, v192, v192, 0
    v_dot2_f32_bf16 v219, v196, v196, 0
    v_dot2_f32_bf16 v216, v193, v221, v216
    v_dot2_f32_bf16 v217, v197, v221, v217
    v_dot2_f32_bf16 v218, v193, v193, v218
    v_dot2_f32_bf16 v219, v197, v197, v219
    v_dot2_f32_bf16 v216, v194, v221, v216
    v_dot2_f32_bf16 v217, v198, v221, v217
    v_dot2_f32_bf16 v218, v194, v194, v218
    v_dot2_f32_bf16 v219, v198, v198, v219
    v_dot2_f32_bf16 v216, v195, v221, v216
    v_dot2_f32_bf16 v217, v199, v221, v217
    v_dot2_f32_bf16 v218, v195, v195, v218
    v_dot2_f32_bf16 v219, v199, v199, v219
    v_lshlrev_b32 v200, 16, v192
    v_and_b32 v201, 0xffff0000, v192
    v_lshlrev_b32 v202, 16, v193
    v_permlane32_swap_b32 v216, v217
    v_permlane32_swap_b32 v218, v219
    v_add_f32 v216, v216, v217
    v_add_f32 v218, v218, v219
    v_and_b32 v203, 0xffff0000, v193
    v_lshlrev_b32 v204, 16, v194
    v_permlane16_swap_b32 v216, v218
    v_add_f32 v216, v216, v218
    v_and_b32 v205, 0xffff0000, v194
    v_lshlrev_b32 v206, 16, v195
    v_add_f32_dpp v216, v216, v216 row_ror:8 row_mask:0xf bank_mask:0xf
    v_and_b32 v207, 0xffff0000, v195
    v_lshlrev_b32 v208, 16, v196
    v_add_f32_dpp v216, v216, v216 row_ror:4 row_mask:0xf bank_mask:0xf
    v_and_b32 v209, 0xffff0000, v196
    v_lshlrev_b32 v210, 16, v197
    v_add_f32_dpp v216, v216, v216 row_ror:2 row_mask:0xf bank_mask:0xf
    v_and_b32 v211, 0xffff0000, v197
    v_lshlrev_b32 v212, 16, v198
    v_add_f32_dpp v216, v216, v216 row_ror:1 row_mask:0xf bank_mask:0xf
    v_mul_f32 v216, 0x3b000000, v216
    v_mov_b32 v217, v216
    v_and_b32 v213, 0xffff0000, v198
    v_lshlrev_b32 v214, 16, v199
    v_permlane16_swap_b32 v216, v217
    v_fma_f32 v217, -v216, v216, v217
    v_max_f32 v217, 0, v217
    v_cvt_pk_bf16_f32 v217, v217, -v216
    v_and_b32 v216, 0xffff0000, v217
    v_lshlrev_b32 v217, 16, v217
    v_add_f32 v217, 0x3727c5ac, v217
    v_cvt_pk_bf16_f32 v217, v217, v217
    v_lshlrev_b32 v217, 16, v217
    v_sqrt_f32 v217, v217
    v_and_b32 v215, 0xffff0000, v199
    v_cvt_pk_bf16_f32 v217, v217, v217
    v_lshlrev_b32 v217, 16, v217
    v_rcp_f32 v218, v217
    s_nop 0
    v_mul_f32 v219, v216, v218
    v_readlane_b32 s30, v218, 0
    v_readlane_b32 s32, v218, 32
    v_readlane_b32 s31, v219, 0
    v_readlane_b32 s33, v219, 32
    s_nop 0
    v_pk_fma_f32 v[200:201], v[200:201], s[30:31], s[30:31] op_sel:[0,0,1] op_sel_hi:[1,0,1]
    v_pk_fma_f32 v[202:203], v[202:203], s[30:31], s[30:31] op_sel:[0,0,1] op_sel_hi:[1,0,1]
    v_pk_fma_f32 v[204:205], v[204:205], s[30:31], s[30:31] op_sel:[0,0,1] op_sel_hi:[1,0,1]
    v_pk_fma_f32 v[206:207], v[206:207], s[30:31], s[30:31] op_sel:[0,0,1] op_sel_hi:[1,0,1]
    v_pk_fma_f32 v[208:209], v[208:209], s[32:33], s[32:33] op_sel:[0,0,1] op_sel_hi:[1,0,1]
    v_pk_fma_f32 v[210:211], v[210:211], s[32:33], s[32:33] op_sel:[0,0,1] op_sel_hi:[1,0,1]
    v_pk_fma_f32 v[212:213], v[212:213], s[32:33], s[32:33] op_sel:[0,0,1] op_sel_hi:[1,0,1]
    v_pk_fma_f32 v[214:215], v[214:215], s[32:33], s[32:33] op_sel:[0,0,1] op_sel_hi:[1,0,1]
    v_cvt_pk_bf16_f32 v192, v200, v201
    v_cvt_pk_bf16_f32 v193, v202, v203
    v_cvt_pk_bf16_f32 v194, v204, v205
    v_cvt_pk_bf16_f32 v195, v206, v207
    v_cvt_pk_bf16_f32 v196, v208, v209
    v_cvt_pk_bf16_f32 v197, v210, v211
    v_cvt_pk_bf16_f32 v198, v212, v213
    v_cvt_pk_bf16_f32 v199, v214, v215
    ds_write_b128 v220, v[192:195] offset:0
    ds_write_b128 v220, v[196:199] offset:1024
    s_mov_b32 exec_lo, 1
    s_mov_b32 exec_hi, 1
    buffer_store_dwordx2 v[216:217], v222, s[44:47], s82 offen sc1
    s_mov_b64 exec, -1
    s_waitcnt vmcnt(1)
    s_waitcnt lgkmcnt(0)
    s_barrier
    ds_read_b64_tr_b16 v[128:129], v6 offset:0
    ds_read_b64_tr_b16 v[130:131], v6 offset:768
    ds_read_b128 v[160:163], v2 offset:0
    ds_read_b128 v[164:167], v2 offset:2048
    ds_read_b128 v[168:171], v4 offset:0
    ds_read_b128 v[172:175], v4 offset:2048
    ds_read_b64_tr_b16 v[132:133], v7 offset:0
    ds_read_b64_tr_b16 v[134:135], v7 offset:768
    ds_read_b64_tr_b16 v[136:137], v8 offset:0
    ds_read_b64_tr_b16 v[138:139], v8 offset:768
    ds_read_b64_tr_b16 v[140:141], v9 offset:0
    ds_read_b64_tr_b16 v[142:143], v9 offset:768
    ds_read_b64_tr_b16 v[144:145], v10 offset:0
    ds_read_b64_tr_b16 v[146:147], v10 offset:768
    ds_read_b64_tr_b16 v[148:149], v11 offset:0
    ds_read_b64_tr_b16 v[150:151], v11 offset:768
    ds_read_b64_tr_b16 v[152:153], v12 offset:0
    ds_read_b64_tr_b16 v[154:155], v12 offset:768
    ds_read_b64_tr_b16 v[156:157], v13 offset:0
    ds_read_b64_tr_b16 v[158:159], v13 offset:768
    s_mul_i32 s58, s58, 0x9e3779b5
    s_add_u32 s58, s58, 0x7f4a7c15
    s_mul_i32 s59, s59, 0x85ebca6d
    s_add_u32 s59, s59, 0x2545f491
    v_mov_b32 v28, s58
    v_mov_b32 v29, s59
    v_mov_b32 v30, 0
    s_waitcnt lgkmcnt(14)
    v_mfma_f32_16x16x32_bf16 v[32:35], v[128:131], v[160:163], 0
    v_mfma_f32_16x16x32_bf16 v[36:39], v[128:131], v[164:167], 0
    ds_read_b64_tr_b16 v[192:193], v227 offset:0
    ds_read_b64_tr_b16 v[194:195], v228 offset:0
    v_mfma_f32_16x16x32_bf16 v[40:43], v[128:131], v[168:171], 0
    ds_read_b64_tr_b16 v[196:197], v227 offset:128
    ds_read_b64_tr_b16 v[198:199], v228 offset:128
    v_mfma_f32_16x16x32_bf16 v[44:47], v[128:131], v[172:175], 0
    ds_read_b64_tr_b16 v[128:129], v6 offset:3072
    ds_read_b64_tr_b16 v[130:131], v6 offset:3840
    s_waitcnt lgkmcnt(15)
    v_mfma_f32_16x16x32_bf16 v[48:51], v[132:135], v[160:163], 0
    ds_read_b128 v[176:179], v3 offset:0
    ds_read_b128 v[180:183], v3 offset:2048
    v_mfma_f32_16x16x32_bf16 v[52:55], v[132:135], v[164:167], 0
    ds_read_b128 v[184:187], v5 offset:0
    ds_read_b128 v[188:191], v5 offset:2048
    v_mfma_f32_16x16x32_bf16 v[56:59], v[132:135], v[168:171], 0
    ds_read_b64_tr_b16 v[200:201], v229 offset:0
    ds_read_b64_tr_b16 v[202:203], v229 offset:40960
    v_mfma_f32_16x16x32_bf16 v[60:63], v[132:135], v[172:175], 0
    ds_read_b64_tr_b16 v[132:133], v7 offset:3072
    ds_read_b64_tr_b16 v[134:135], v7 offset:3840
    v_mfma_f32_16x16x32_bf16 v[64:67], v[136:139], v[160:163], 0
    ds_read_b64_tr_b16 v[204:205], v230 offset:0
    ds_read_b64_tr_b16 v[206:207], v230 offset:40960
    v_mfma_f32_16x16x32_bf16 v[68:71], v[136:139], v[164:167], 0
    ds_read_b64_tr_b16 v[244:245], v226 offset:0
    ds_read_b64_tr_b16 v[246:247], v226 offset:768
    v_mfma_f32_16x16x32_bf16 v[72:75], v[136:139], v[168:171], 0
    ds_read_b64_tr_b16 v[248:249], v226 offset:64
    ds_read_b64_tr_b16 v[250:251], v226 offset:832
    v_mfma_f32_16x16x32_bf16 v[76:79], v[136:139], v[172:175], 0
    ds_read_b64_tr_b16 v[136:137], v8 offset:3072
    ds_read_b64_tr_b16 v[138:139], v8 offset:3840
    s_waitcnt lgkmcnt(15)
    v_mfma_f32_16x16x32_bf16 v[80:83], v[140:143], v[160:163], 0
    ds_read_b64_tr_b16 v[252:253], v226 offset:128
    ds_read_b64_tr_b16 v[254:255], v226 offset:896
    v_mfma_f32_16x16x32_bf16 v[84:87], v[140:143], v[164:167], 0
    v_mfma_f32_16x16x32_bf16 v[88:91], v[140:143], v[168:171], 0
    s_waitcnt lgkmcnt(0)
    buffer_store_dwordx4 v[192:195], v14, s[44:47], s83 offen sc1
    v_mfma_f32_16x16x32_bf16 v[92:95], v[140:143], v[172:175], 0
    ds_read_b64_tr_b16 v[140:141], v9 offset:3072
    ds_read_b64_tr_b16 v[142:143], v9 offset:3840
    v_mfma_f32_16x16x32_bf16 v[96:99], v[144:147], v[160:163], 0
    v_mfma_f32_16x16x32_bf16 v[216:219], v[244:247], v[232:235], 0
    v_mfma_f32_16x16x32_bf16 v[216:219], v[248:251], v[236:239], v[216:219]
    v_mfma_f32_16x16x32_bf16 v[216:219], v[252:255], v[240:243], v[216:219]
    v_mfma_f32_16x16x32_bf16 v[100:103], v[144:147], v[164:167], 0
    ds_read_b64_tr_b16 v[144:145], v10 offset:3072
    ds_read_b64_tr_b16 v[146:147], v10 offset:3840
    v_mfma_f32_16x16x32_bf16 v[104:107], v[148:151], v[160:163], 0
    v_mfma_f32_16x16x32_bf16 v[108:111], v[148:151], v[164:167], 0
    ds_read_b64_tr_b16 v[148:149], v11 offset:3072
    ds_read_b64_tr_b16 v[150:151], v11 offset:3840
    v_mfma_f32_16x16x32_bf16 v[112:115], v[152:155], v[160:163], 0
    v_mfma_f32_16x16x32_bf16 v[116:119], v[152:155], v[164:167], 0
    ds_read_b64_tr_b16 v[152:153], v12 offset:3072
    ds_read_b64_tr_b16 v[154:155], v12 offset:3840
    v_mfma_f32_16x16x32_bf16 v[120:123], v[156:159], v[160:163], 0
    v_mfma_f32_16x16x32_bf16 v[124:127], v[156:159], v[164:167], 0
    ds_read_b64_tr_b16 v[156:157], v13 offset:3072
    ds_read_b64_tr_b16 v[158:159], v13 offset:3840
    s_waitcnt lgkmcnt(8)
    v_mfma_f32_16x16x32_bf16 v[32:35], v[128:131], v[176:179], v[32:35]
    v_mfma_f32_16x16x32_bf16 v[36:39], v[128:131], v[180:183], v[36:39]
    buffer_store_dwordx4 v[196:199], v14, s[44:47], s83 offen offset:1024 sc1
    v_mfma_f32_16x16x32_bf16 v[40:43], v[128:131], v[184:187], v[40:43]
    v_mfma_f32_16x16x32_bf16 v[44:47], v[128:131], v[188:191], v[44:47]
    s_waitcnt lgkmcnt(0)
    s_barrier
    ds_read_b64_tr_b16 v[128:129], v6 offset:10240
    ds_read_b64_tr_b16 v[130:131], v6 offset:11008
    v_mfma_f32_16x16x32_bf16 v[48:51], v[132:135], v[176:179], v[48:51]
    ds_read_b128 v[160:163], v2 offset:10240
    ds_read_b128 v[164:167], v2 offset:12288
    v_mfma_f32_16x16x32_bf16 v[52:55], v[132:135], v[180:183], v[52:55]
    ds_read_b128 v[168:171], v4 offset:10240
    ds_read_b128 v[172:175], v4 offset:12288
    v_mfma_f32_16x16x32_bf16 v[56:59], v[132:135], v[184:187], v[56:59]
    v_mfma_f32_16x16x32_bf16 v[60:63], v[132:135], v[188:191], v[60:63]
    ds_read_b64_tr_b16 v[132:133], v7 offset:10240
    ds_read_b64_tr_b16 v[134:135], v7 offset:11008
    v_mfma_f32_16x16x32_bf16 v[64:67], v[136:139], v[176:179], v[64:67]
    buffer_store_dwordx4 v[200:203], v14, s[44:47], s89 offen sc1
    v_mfma_f32_16x16x32_bf16 v[68:71], v[136:139], v[180:183], v[68:71]
    v_mfma_f32_16x16x32_bf16 v[72:75], v[136:139], v[184:187], v[72:75]
    v_mfma_f32_16x16x32_bf16 v[76:79], v[136:139], v[188:191], v[76:79]
    ds_read_b64_tr_b16 v[136:137], v8 offset:10240
    ds_read_b64_tr_b16 v[138:139], v8 offset:11008
    v_mfma_f32_16x16x32_bf16 v[80:83], v[140:143], v[176:179], v[80:83]
    buffer_store_dwordx4 v[204:207], v15, s[44:47], s89 offen sc1
    v_mfma_f32_16x16x32_bf16 v[84:87], v[140:143], v[180:183], v[84:87]
    v_mfma_f32_16x16x32_bf16 v[88:91], v[140:143], v[184:187], v[88:91]
    s_mov_b32 exec_lo, 0x70007
    s_mov_b32 exec_hi, 0x70007
    buffer_store_dwordx4 v[216:219], v231, s[44:47], s97 offen sc1
    s_mov_b64 exec, -1
    v_mfma_f32_16x16x32_bf16 v[92:95], v[140:143], v[188:191], v[92:95]
    ds_read_b64_tr_b16 v[140:141], v9 offset:10240
    ds_read_b64_tr_b16 v[142:143], v9 offset:11008
    v_mfma_f32_16x16x32_bf16 v[96:99], v[144:147], v[176:179], v[96:99]
    v_mfma_f32_16x16x32_bf16 v[100:103], v[144:147], v[180:183], v[100:103]
    ds_read_b64_tr_b16 v[144:145], v10 offset:10240
    ds_read_b64_tr_b16 v[146:147], v10 offset:11008
    v_mfma_f32_16x16x32_bf16 v[104:107], v[148:151], v[176:179], v[104:107]
    v_mfma_f32_16x16x32_bf16 v[108:111], v[148:151], v[180:183], v[108:111]
    ds_read_b64_tr_b16 v[148:149], v11 offset:10240
    ds_read_b64_tr_b16 v[150:151], v11 offset:11008
    v_mfma_f32_16x16x32_bf16 v[112:115], v[152:155], v[176:179], v[112:115]
    v_mfma_f32_16x16x32_bf16 v[116:119], v[152:155], v[180:183], v[116:119]
    ds_read_b64_tr_b16 v[152:153], v12 offset:10240
    ds_read_b64_tr_b16 v[154:155], v12 offset:11008
    v_mfma_f32_16x16x32_bf16 v[120:123], v[156:159], v[176:179], v[120:123]
    v_mfma_f32_16x16x32_bf16 v[124:127], v[156:159], v[180:183], v[124:127]
    ds_read_b64_tr_b16 v[156:157], v13 offset:10240
    ds_read_b64_tr_b16 v[158:159], v13 offset:11008
    s_waitcnt lgkmcnt(8)
    v_mfma_f32_16x16x32_bf16 v[32:35], v[128:131], v[160:163], v[32:35]
    v_mfma_f32_16x16x32_bf16 v[36:39], v[128:131], v[164:167], v[36:39]
    s_lshl_b32 s36, s2, 5
    s_add_u32 s36, s36, 4096
    v_mfma_f32_16x16x32_bf16 v[40:43], v[128:131], v[168:171], v[40:43]
    s_lshl_b32 s61, s3, 28
    s_add_u32 s36, s36, s61
    v_mfma_f32_16x16x32_bf16 v[44:47], v[128:131], v[172:175], v[44:47]
    ds_read_b64_tr_b16 v[128:129], v6 offset:13312
    ds_read_b64_tr_b16 v[130:131], v6 offset:14080
    v_mfma_f32_16x16x32_bf16 v[48:51], v[132:135], v[160:163], v[48:51]
    ds_read_b128 v[176:179], v3 offset:10240
    ds_read_b128 v[180:183], v3 offset:12288
    v_mfma_f32_16x16x32_bf16 v[52:55], v[132:135], v[164:167], v[52:55]
    ds_read_b128 v[184:187], v5 offset:10240
    ds_read_b128 v[188:191], v5 offset:12288
    v_mfma_f32_16x16x32_bf16 v[56:59], v[132:135], v[168:171], v[56:59]
    s_and_b32 s79, s5, 3
    s_lshl_b32 s61, s4, 2
    v_mfma_f32_16x16x32_bf16 v[60:63], v[132:135], v[172:175], v[60:63]
    ds_read_b64_tr_b16 v[132:133], v7 offset:13312
    ds_read_b64_tr_b16 v[134:135], v7 offset:14080
    v_mfma_f32_16x16x32_bf16 v[64:67], v[136:139], v[160:163], v[64:67]
    s_add_u32 s79, s79, s61
    s_lshr_b32 s80, s5, 2
    v_mfma_f32_16x16x32_bf16 v[68:71], v[136:139], v[164:167], v[68:71]
    s_lshl_b32 s74, s80, 2
    s_add_u32 s74, s74, s3
    v_mfma_f32_16x16x32_bf16 v[72:75], v[136:139], v[168:171], v[72:75]
    s_mul_i32 s78, s80, 172
    s_mul_i32 s61, s3, 11
    v_mfma_f32_16x16x32_bf16 v[76:79], v[136:139], v[172:175], v[76:79]
    ds_read_b64_tr_b16 v[136:137], v8 offset:13312
    ds_read_b64_tr_b16 v[138:139], v8 offset:14080
    v_mfma_f32_16x16x32_bf16 v[80:83], v[140:143], v[160:163], v[80:83]
    s_add_u32 s78, s78, s61
    s_lshl_b32 s78, s78, 10
    v_mfma_f32_16x16x32_bf16 v[84:87], v[140:143], v[164:167], v[84:87]
    s_add_u32 s78, s78, 12582912
    s_and_b32 s88, s71, s86
    v_mfma_f32_16x16x32_bf16 v[88:91], v[140:143], v[168:171], v[88:91]
    v_mfma_f32_16x16x32_bf16 v[92:95], v[140:143], v[172:175], v[92:95]
    ds_read_b64_tr_b16 v[140:141], v9 offset:13312
    ds_read_b64_tr_b16 v[142:143], v9 offset:14080
    s_waitcnt lgkmcnt(12)
    v_mfma_f32_16x16x32_bf16 v[96:99], v[144:147], v[160:163], v[96:99]
    v_mfma_f32_16x16x32_bf16 v[100:103], v[144:147], v[164:167], v[100:103]
    ds_read_b64_tr_b16 v[144:145], v10 offset:13312
    ds_read_b64_tr_b16 v[146:147], v10 offset:14080
    v_mfma_f32_16x16x32_bf16 v[104:107], v[148:151], v[160:163], v[104:107]
    v_mfma_f32_16x16x32_bf16 v[108:111], v[148:151], v[164:167], v[108:111]
    ds_read_b64_tr_b16 v[148:149], v11 offset:13312
    ds_read_b64_tr_b16 v[150:151], v11 offset:14080
    v_mfma_f32_16x16x32_bf16 v[112:115], v[152:155], v[160:163], v[112:115]
    v_mfma_f32_16x16x32_bf16 v[116:119], v[152:155], v[164:167], v[116:119]
    ds_read_b64_tr_b16 v[152:153], v12 offset:13312
    ds_read_b64_tr_b16 v[154:155], v12 offset:14080
    v_mfma_f32_16x16x32_bf16 v[120:123], v[156:159], v[160:163], v[120:123]
    v_mfma_f32_16x16x32_bf16 v[124:127], v[156:159], v[164:167], v[124:127]
    ds_read_b64_tr_b16 v[156:157], v13 offset:13312
    ds_read_b64_tr_b16 v[158:159], v13 offset:14080
    s_waitcnt lgkmcnt(8)
    v_mfma_f32_16x16x32_bf16 v[32:35], v[128:131], v[176:179], v[32:35]
    v_mfma_f32_16x16x32_bf16 v[36:39], v[128:131], v[180:183], v[36:39]
    s_lshl_b32 s88, s88, 30
    s_add_u32 s61, s3, 0
    v_mfma_f32_16x16x32_bf16 v[40:43], v[128:131], v[184:187], v[40:43]
    s_and_b32 s61, s61, 3
    s_mul_i32 s61, s61, 44032
    v_mfma_f32_16x16x32_bf16 v[44:47], v[128:131], v[188:191], v[44:47]
    s_waitcnt lgkmcnt(0)
    s_barrier
    ds_read_b64_tr_b16 v[128:129], v6 offset:20480
    ds_read_b64_tr_b16 v[130:131], v6 offset:21248
    v_mfma_f32_16x16x32_bf16 v[48:51], v[132:135], v[176:179], v[48:51]
    ds_read_b128 v[160:163], v2 offset:20480
    ds_read_b128 v[164:167], v2 offset:22528
    v_mfma_f32_16x16x32_bf16 v[52:55], v[132:135], v[180:183], v[52:55]
    ds_read_b128 v[168:171], v4 offset:20480
    ds_read_b128 v[172:175], v4 offset:22528
    v_mfma_f32_16x16x32_bf16 v[56:59], v[132:135], v[184:187], v[56:59]
    s_add_u32 s92, s61, s78
    s_add_u32 s61, s3, 1
    v_mfma_f32_16x16x32_bf16 v[60:63], v[132:135], v[188:191], v[60:63]
    ds_read_b64_tr_b16 v[132:133], v7 offset:20480
    ds_read_b64_tr_b16 v[134:135], v7 offset:21248
    v_mfma_f32_16x16x32_bf16 v[64:67], v[136:139], v[176:179], v[64:67]
    s_and_b32 s61, s61, 3
    s_mul_i32 s61, s61, 44032
    v_mfma_f32_16x16x32_bf16 v[68:71], v[136:139], v[180:183], v[68:71]
    s_add_u32 s93, s61, s78
    s_add_u32 s61, s3, 2
    v_mfma_f32_16x16x32_bf16 v[72:75], v[136:139], v[184:187], v[72:75]
    s_and_b32 s61, s61, 3
    s_mul_i32 s61, s61, 44032
    v_mfma_f32_16x16x32_bf16 v[76:79], v[136:139], v[188:191], v[76:79]
    ds_read_b64_tr_b16 v[136:137], v8 offset:20480
    ds_read_b64_tr_b16 v[138:139], v8 offset:21248
    v_mfma_f32_16x16x32_bf16 v[80:83], v[140:143], v[176:179], v[80:83]
    s_add_u32 s94, s61, s78
    s_add_u32 s61, s3, 3
    v_mfma_f32_16x16x32_bf16 v[84:87], v[140:143], v[180:183], v[84:87]
    s_and_b32 s61, s61, 3
    s_mul_i32 s61, s61, 44032
    v_mfma_f32_16x16x32_bf16 v[88:91], v[140:143], v[184:187], v[88:91]
    v_mfma_f32_16x16x32_bf16 v[92:95], v[140:143], v[188:191], v[92:95]
    ds_read_b64_tr_b16 v[140:141], v9 offset:20480
    ds_read_b64_tr_b16 v[142:143], v9 offset:21248
    v_mfma_f32_16x16x32_bf16 v[96:99], v[144:147], v[176:179], v[96:99]
    v_mfma_f32_16x16x32_bf16 v[100:103], v[144:147], v[180:183], v[100:103]
    ds_read_b64_tr_b16 v[144:145], v10 offset:20480
    ds_read_b64_tr_b16 v[146:147], v10 offset:21248
    v_mfma_f32_16x16x32_bf16 v[104:107], v[148:151], v[176:179], v[104:107]
    v_mfma_f32_16x16x32_bf16 v[108:111], v[148:151], v[180:183], v[108:111]
    ds_read_b64_tr_b16 v[148:149], v11 offset:20480
    ds_read_b64_tr_b16 v[150:151], v11 offset:21248
    v_mfma_f32_16x16x32_bf16 v[112:115], v[152:155], v[176:179], v[112:115]
    v_mfma_f32_16x16x32_bf16 v[116:119], v[152:155], v[180:183], v[116:119]
    ds_read_b64_tr_b16 v[152:153], v12 offset:20480
    ds_read_b64_tr_b16 v[154:155], v12 offset:21248
    v_mfma_f32_16x16x32_bf16 v[120:123], v[156:159], v[176:179], v[120:123]
    v_mfma_f32_16x16x32_bf16 v[124:127], v[156:159], v[180:183], v[124:127]
    ds_read_b64_tr_b16 v[156:157], v13 offset:20480
    ds_read_b64_tr_b16 v[158:159], v13 offset:21248
    s_waitcnt lgkmcnt(8)
    v_mfma_f32_16x16x32_bf16 v[32:35], v[128:131], v[160:163], v[32:35]
    v_mfma_f32_16x16x32_bf16 v[36:39], v[128:131], v[164:167], v[36:39]
    s_add_u32 s95, s61, s78
    s_lshl_b32 s72, s79, 2
    v_mfma_f32_16x16x32_bf16 v[40:43], v[128:131], v[168:171], v[40:43]
    s_add_u32 s72, s72, s3
    s_mul_i32 s73, s79, 172
    v_mfma_f32_16x16x32_bf16 v[44:47], v[128:131], v[172:175], v[44:47]
    ds_read_b64_tr_b16 v[128:129], v6 offset:23552
    ds_read_b64_tr_b16 v[130:131], v6 offset:24320
    v_mfma_f32_16x16x32_bf16 v[48:51], v[132:135], v[160:163], v[48:51]
    ds_read_b128 v[176:179], v3 offset:20480
    ds_read_b128 v[180:183], v3 offset:22528
    v_mfma_f32_16x16x32_bf16 v[52:55], v[132:135], v[164:167], v[52:55]
    ds_read_b128 v[184:187], v5 offset:20480
    ds_read_b128 v[188:191], v5 offset:22528
    v_mfma_f32_16x16x32_bf16 v[56:59], v[132:135], v[168:171], v[56:59]
    s_mul_i32 s61, s3, 11
    s_add_u32 s73, s73, s61
    v_mfma_f32_16x16x32_bf16 v[60:63], v[132:135], v[172:175], v[60:63]
    ds_read_b64_tr_b16 v[132:133], v7 offset:23552
    ds_read_b64_tr_b16 v[134:135], v7 offset:24320
    v_mfma_f32_16x16x32_bf16 v[64:67], v[136:139], v[160:163], v[64:67]
    s_lshl_b32 s73, s73, 10
    s_add_u32 s73, s73, 4194304
    v_mfma_f32_16x16x32_bf16 v[68:71], v[136:139], v[164:167], v[68:71]
    s_mul_i32 s83, s87, 86
    s_xor_b32 s61, s87, 1
    v_mfma_f32_16x16x32_bf16 v[72:75], v[136:139], v[168:171], v[72:75]
    s_mul_i32 s84, s61, 86
    s_lshr_b32 s61, s68, 6
    v_mfma_f32_16x16x32_bf16 v[76:79], v[136:139], v[172:175], v[76:79]
    ds_read_b64_tr_b16 v[136:137], v8 offset:23552
    ds_read_b64_tr_b16 v[138:139], v8 offset:24320
    v_mfma_f32_16x16x32_bf16 v[80:83], v[140:143], v[160:163], v[80:83]
    s_add_u32 s83, s83, s61
    s_add_u32 s84, s84, s61
    v_mfma_f32_16x16x32_bf16 v[84:87], v[140:143], v[164:167], v[84:87]
    s_add_u32 s85, s83, 2
    s_add_u32 s83, s83, s71
    v_mfma_f32_16x16x32_bf16 v[88:91], v[140:143], v[168:171], v[88:91]
    v_mfma_f32_16x16x32_bf16 v[92:95], v[140:143], v[172:175], v[92:95]
    ds_read_b64_tr_b16 v[140:141], v9 offset:23552
    ds_read_b64_tr_b16 v[142:143], v9 offset:24320
    s_waitcnt lgkmcnt(12)
    v_mfma_f32_16x16x32_bf16 v[96:99], v[144:147], v[160:163], v[96:99]
    v_mfma_f32_16x16x32_bf16 v[100:103], v[144:147], v[164:167], v[100:103]
    ds_read_b64_tr_b16 v[144:145], v10 offset:23552
    ds_read_b64_tr_b16 v[146:147], v10 offset:24320
    v_mfma_f32_16x16x32_bf16 v[104:107], v[148:151], v[160:163], v[104:107]
    v_mfma_f32_16x16x32_bf16 v[108:111], v[148:151], v[164:167], v[108:111]
    ds_read_b64_tr_b16 v[148:149], v11 offset:23552
    ds_read_b64_tr_b16 v[150:151], v11 offset:24320
    v_mfma_f32_16x16x32_bf16 v[112:115], v[152:155], v[160:163], v[112:115]
    v_mfma_f32_16x16x32_bf16 v[116:119], v[152:155], v[164:167], v[116:119]
    ds_read_b64_tr_b16 v[152:153], v12 offset:23552
    ds_read_b64_tr_b16 v[154:155], v12 offset:24320
    v_mfma_f32_16x16x32_bf16 v[120:123], v[156:159], v[160:163], v[120:123]
    v_mfma_f32_16x16x32_bf16 v[124:127], v[156:159], v[164:167], v[124:127]
    ds_read_b64_tr_b16 v[156:157], v13 offset:23552
    ds_read_b64_tr_b16 v[158:159], v13 offset:24320
    s_waitcnt lgkmcnt(8)
    v_mfma_f32_16x16x32_bf16 v[32:35], v[128:131], v[176:179], v[32:35]
    v_mfma_f32_16x16x32_bf16 v[36:39], v[128:131], v[180:183], v[36:39]
    v_mfma_f32_16x16x32_bf16 v[40:43], v[128:131], v[184:187], v[40:43]
    v_mfma_f32_16x16x32_bf16 v[44:47], v[128:131], v[188:191], v[44:47]
    s_waitcnt vmcnt(0)
    s_waitcnt lgkmcnt(0)
    s_barrier
    ds_read_b64_tr_b16 v[128:129], v6 offset:0
    ds_read_b64_tr_b16 v[130:131], v6 offset:768
    v_mfma_f32_16x16x32_bf16 v[48:51], v[132:135], v[176:179], v[48:51]
    ds_read_b128 v[160:163], v2 offset:0
    ds_read_b128 v[164:167], v2 offset:2048
    v_mfma_f32_16x16x32_bf16 v[52:55], v[132:135], v[180:183], v[52:55]
    ds_read_b128 v[168:171], v4 offset:0
    ds_read_b128 v[172:175], v4 offset:2048
    v_mfma_f32_16x16x32_bf16 v[56:59], v[132:135], v[184:187], v[56:59]
    s_add_u32 s84, s84, s71
    s_lshl_b32 s83, s83, 10
    v_mfma_f32_16x16x32_bf16 v[60:63], v[132:135], v[188:191], v[60:63]
    ds_read_b64_tr_b16 v[132:133], v7 offset:0
    ds_read_b64_tr_b16 v[134:135], v7 offset:768
    v_mfma_f32_16x16x32_bf16 v[64:67], v[136:139], v[176:179], v[64:67]
    s_mov_b64 exec, 1
    buffer_store_dwordx2 v[28:29], v30, s[44:47], s36 offen sc1
    s_mov_b64 exec, -1
    v_mfma_f32_16x16x32_bf16 v[68:71], v[136:139], v[180:183], v[68:71]
    s_lshl_b32 s84, s84, 10
    s_lshl_b32 s85, s85, 10
    v_mfma_f32_16x16x32_bf16 v[72:75], v[136:139], v[184:187], v[72:75]
    s_cmp_ge_u32 s7, 14
    s_cselect_b32 s61, 1073741824, 4194304
    v_mfma_f32_16x16x32_bf16 v[76:79], v[136:139], v[188:191], v[76:79]
    ds_read_b64_tr_b16 v[136:137], v8 offset:0
    ds_read_b64_tr_b16 v[138:139], v8 offset:768
    v_mfma_f32_16x16x32_bf16 v[80:83], v[140:143], v[176:179], v[80:83]
    s_add_u32 s83, s83, s61
    s_add_u32 s84, s84, s61
    v_mfma_f32_16x16x32_bf16 v[84:87], v[140:143], v[180:183], v[84:87]
    s_cmp_eq_u32 s7, 15
    s_cselect_b32 s61, 1073741824, 4194304
    v_mfma_f32_16x16x32_bf16 v[88:91], v[140:143], v[184:187], v[88:91]
    s_add_u32 s85, s85, s61
    s_lshl_b32 s37, s96, 8
    v_mfma_f32_16x16x32_bf16 v[92:95], v[140:143], v[188:191], v[92:95]
    ds_read_b64_tr_b16 v[140:141], v9 offset:0
    ds_read_b64_tr_b16 v[142:143], v9 offset:768
    v_mfma_f32_16x16x32_bf16 v[96:99], v[144:147], v[176:179], v[96:99]
    s_lshl_b32 s61, s86, 7
    s_add_u32 s37, s37, s61
    v_mfma_f32_16x16x32_bf16 v[100:103], v[144:147], v[180:183], v[100:103]
    ds_read_b64_tr_b16 v[144:145], v10 offset:0
    ds_read_b64_tr_b16 v[146:147], v10 offset:768
    v_mfma_f32_16x16x32_bf16 v[104:107], v[148:151], v[176:179], v[104:107]
    s_lshl_b32 s61, s71, 3
    s_add_u32 s37, s37, s61
    v_mfma_f32_16x16x32_bf16 v[108:111], v[148:151], v[180:183], v[108:111]
    ds_read_b64_tr_b16 v[148:149], v11 offset:0
    ds_read_b64_tr_b16 v[150:151], v11 offset:768
    v_mfma_f32_16x16x32_bf16 v[112:115], v[152:155], v[176:179], v[112:115]
    v_mfma_f32_16x16x32_bf16 v[116:119], v[152:155], v[180:183], v[116:119]
    ds_read_b64_tr_b16 v[152:153], v12 offset:0
    ds_read_b64_tr_b16 v[154:155], v12 offset:768
    v_mfma_f32_16x16x32_bf16 v[120:123], v[156:159], v[176:179], v[120:123]
    v_mfma_f32_16x16x32_bf16 v[124:127], v[156:159], v[180:183], v[124:127]
    ds_read_b64_tr_b16 v[156:157], v13 offset:0
    ds_read_b64_tr_b16 v[158:159], v13 offset:768
    s_waitcnt lgkmcnt(8)
    v_mfma_f32_16x16x32_bf16 v[32:35], v[128:131], v[160:163], v[32:35]
    v_mfma_f32_16x16x32_bf16 v[36:39], v[128:131], v[164:167], v[36:39]
    s_add_u32 s37, s37, 65536
    s_lshl_b32 s75, s72, 14
    v_mfma_f32_16x16x32_bf16 v[40:43], v[128:131], v[168:171], v[40:43]
    s_lshl_b32 s61, s80, 7
    s_add_u32 s75, s75, s61
    v_mfma_f32_16x16x32_bf16 v[44:47], v[128:131], v[172:175], v[44:47]
    ds_read_b64_tr_b16 v[128:129], v6 offset:3072
    ds_read_b64_tr_b16 v[130:131], v6 offset:3840
    v_mfma_f32_16x16x32_bf16 v[48:51], v[132:135], v[160:163], v[48:51]
    ds_read_b128 v[176:179], v3 offset:0
    ds_read_b128 v[180:183], v3 offset:2048
    v_mfma_f32_16x16x32_bf16 v[52:55], v[132:135], v[164:167], v[52:55]
    ds_read_b128 v[184:187], v5 offset:0
    ds_read_b128 v[188:191], v5 offset:2048
    v_mfma_f32_16x16x32_bf16 v[56:59], v[132:135], v[168:171], v[56:59]
    s_add_u32 s76, s75, 8192
    s_lshl_b32 s77, s74, 17
    v_mfma_f32_16x16x32_bf16 v[60:63], v[132:135], v[172:175], v[60:63]
    ds_read_b64_tr_b16 v[132:133], v7 offset:3072
    ds_read_b64_tr_b16 v[134:135], v7 offset:3840
    v_mfma_f32_16x16x32_bf16 v[64:67], v[136:139], v[160:163], v[64:67]
    s_lshl_b32 s61, s79, 8
    s_add_u32 s77, s77, s61
    v_mfma_f32_16x16x32_bf16 v[68:71], v[136:139], v[164:167], v[68:71]
    s_add_u32 s77, s77, 16777216
    s_add_u32 s81, s77, 65536
    v_mfma_f32_16x16x32_bf16 v[72:75], v[136:139], v[168:171], v[72:75]
    v_and_b32 v20, 48, v1
    v_add_u32 v20, 61440, v20
    v_mfma_f32_16x16x32_bf16 v[76:79], v[136:139], v[172:175], v[76:79]
    ds_read_b64_tr_b16 v[136:137], v8 offset:3072
    ds_read_b64_tr_b16 v[138:139], v8 offset:3840
    v_mfma_f32_16x16x32_bf16 v[80:83], v[140:143], v[160:163], v[80:83]
    s_lshl_b32 s61, s71, 8
    v_add_u32 v21, s61, v20
    v_mfma_f32_16x16x32_bf16 v[84:87], v[140:143], v[164:167], v[84:87]
    v_lshl_add_u32 v22, v16, 4, s56
    v_lshl_add_u32 v23, v16, 4, s60
    v_mfma_f32_16x16x32_bf16 v[88:91], v[140:143], v[168:171], v[88:91]
    v_mfma_f32_16x16x32_bf16 v[92:95], v[140:143], v[172:175], v[92:95]
    ds_read_b64_tr_b16 v[140:141], v9 offset:3072
    ds_read_b64_tr_b16 v[142:143], v9 offset:3840
    s_waitcnt lgkmcnt(12)
    v_mfma_f32_16x16x32_bf16 v[96:99], v[144:147], v[160:163], v[96:99]
    v_mfma_f32_16x16x32_bf16 v[100:103], v[144:147], v[164:167], v[100:103]
    ds_read_b64_tr_b16 v[144:145], v10 offset:3072
    ds_read_b64_tr_b16 v[146:147], v10 offset:3840
    v_mfma_f32_16x16x32_bf16 v[104:107], v[148:151], v[160:163], v[104:107]
    v_mfma_f32_16x16x32_bf16 v[108:111], v[148:151], v[164:167], v[108:111]
    ds_read_b64_tr_b16 v[148:149], v11 offset:3072
    ds_read_b64_tr_b16 v[150:151], v11 offset:3840
    v_mfma_f32_16x16x32_bf16 v[112:115], v[152:155], v[160:163], v[112:115]
    v_mfma_f32_16x16x32_bf16 v[116:119], v[152:155], v[164:167], v[116:119]
    ds_read_b64_tr_b16 v[152:153], v12 offset:3072
    ds_read_b64_tr_b16 v[154:155], v12 offset:3840
    v_mfma_f32_16x16x32_bf16 v[120:123], v[156:159], v[160:163], v[120:123]
    v_mfma_f32_16x16x32_bf16 v[124:127], v[156:159], v[164:167], v[124:127]
    ds_read_b64_tr_b16 v[156:157], v13 offset:3072
    ds_read_b64_tr_b16 v[158:159], v13 offset:3840
    s_waitcnt lgkmcnt(8)
    v_mfma_f32_16x16x32_bf16 v[32:35], v[128:131], v[176:179], v[32:35]
    v_mfma_f32_16x16x32_bf16 v[36:39], v[128:131], v[180:183], v[36:39]
    v_min_u32 v26, 5, v1
    v_lshrrev_b32 v24, 1, v26
    v_mfma_f32_16x16x32_bf16 v[40:43], v[128:131], v[184:187], v[40:43]
    s_mul_i32 s61, s3, 15
    s_lshr_b32 s61, s61, 2
    v_mfma_f32_16x16x32_bf16 v[44:47], v[128:131], v[188:191], v[44:47]
    s_waitcnt lgkmcnt(0)
    s_barrier
    ds_read_b64_tr_b16 v[128:129], v6 offset:10240
    ds_read_b64_tr_b16 v[130:131], v6 offset:11008
    v_mfma_f32_16x16x32_bf16 v[48:51], v[132:135], v[176:179], v[48:51]
    ds_read_b128 v[160:163], v2 offset:10240
    ds_read_b128 v[164:167], v2 offset:12288
    v_mfma_f32_16x16x32_bf16 v[52:55], v[132:135], v[180:183], v[52:55]
    ds_read_b128 v[168:171], v4 offset:10240
    ds_read_b128 v[172:175], v4 offset:12288
    v_mfma_f32_16x16x32_bf16 v[56:59], v[132:135], v[184:187], v[56:59]
    v_add_u32 v24, s61, v24
    v_min_u32 v24, 14, v24
    v_mfma_f32_16x16x32_bf16 v[60:63], v[132:135], v[188:191], v[60:63]
    ds_read_b64_tr_b16 v[132:133], v7 offset:10240
    ds_read_b64_tr_b16 v[134:135], v7 offset:11008
    v_mfma_f32_16x16x32_bf16 v[64:67], v[136:139], v[176:179], v[64:67]
    v_and_b32 v26, 1, v26
    v_lshlrev_b32 v24, 12, v24
    v_mfma_f32_16x16x32_bf16 v[68:71], v[136:139], v[180:183], v[68:71]
    v_lshl_add_u32 v24, v26, 3, v24
    s_lshl_b32 s61, s79, 7
    v_mfma_f32_16x16x32_bf16 v[72:75], v[136:139], v[184:187], v[72:75]
    s_add_u32 s61, s61, 65536
    v_add_u32 v24, s61, v24
    v_mfma_f32_16x16x32_bf16 v[76:79], v[136:139], v[188:191], v[76:79]
    ds_read_b64_tr_b16 v[136:137], v8 offset:10240
    ds_read_b64_tr_b16 v[138:139], v8 offset:11008
    v_mfma_f32_16x16x32_bf16 v[80:83], v[140:143], v[176:179], v[80:83]
    v_add_u32 v27, s56, v14
    v_mfma_f32_16x16x32_bf16 v[84:87], v[140:143], v[180:183], v[84:87]
    v_mfma_f32_16x16x32_bf16 v[88:91], v[140:143], v[184:187], v[88:91]
    v_mfma_f32_16x16x32_bf16 v[92:95], v[140:143], v[188:191], v[92:95]
    ds_read_b64_tr_b16 v[140:141], v9 offset:10240
    ds_read_b64_tr_b16 v[142:143], v9 offset:11008
    v_mfma_f32_16x16x32_bf16 v[96:99], v[144:147], v[176:179], v[96:99]
    v_mfma_f32_16x16x32_bf16 v[100:103], v[144:147], v[180:183], v[100:103]
    ds_read_b64_tr_b16 v[144:145], v10 offset:10240
    ds_read_b64_tr_b16 v[146:147], v10 offset:11008
    v_mfma_f32_16x16x32_bf16 v[104:107], v[148:151], v[176:179], v[104:107]
    v_mfma_f32_16x16x32_bf16 v[108:111], v[148:151], v[180:183], v[108:111]
    ds_read_b64_tr_b16 v[148:149], v11 offset:10240
    ds_read_b64_tr_b16 v[150:151], v11 offset:11008
    v_mfma_f32_16x16x32_bf16 v[112:115], v[152:155], v[176:179], v[112:115]
    v_mfma_f32_16x16x32_bf16 v[116:119], v[152:155], v[180:183], v[116:119]
    ds_read_b64_tr_b16 v[152:153], v12 offset:10240
    ds_read_b64_tr_b16 v[154:155], v12 offset:11008
    v_mfma_f32_16x16x32_bf16 v[120:123], v[156:159], v[176:179], v[120:123]
    v_mfma_f32_16x16x32_bf16 v[124:127], v[156:159], v[180:183], v[124:127]
    ds_read_b64_tr_b16 v[156:157], v13 offset:10240
    ds_read_b64_tr_b16 v[158:159], v13 offset:11008
    s_waitcnt lgkmcnt(8)
    v_mfma_f32_16x16x32_bf16 v[32:35], v[128:131], v[160:163], v[32:35]
    v_mfma_f32_16x16x32_bf16 v[36:39], v[128:131], v[164:167], v[36:39]
    v_mfma_f32_16x16x32_bf16 v[40:43], v[128:131], v[168:171], v[40:43]
    v_mfma_f32_16x16x32_bf16 v[44:47], v[128:131], v[172:175], v[44:47]
    ds_read_b64_tr_b16 v[128:129], v6 offset:13312
    ds_read_b64_tr_b16 v[130:131], v6 offset:14080
    v_mfma_f32_16x16x32_bf16 v[48:51], v[132:135], v[160:163], v[48:51]
    ds_read_b128 v[176:179], v3 offset:10240
    ds_read_b128 v[180:183], v3 offset:12288
    v_mfma_f32_16x16x32_bf16 v[52:55], v[132:135], v[164:167], v[52:55]
    ds_read_b128 v[184:187], v5 offset:10240
    ds_read_b128 v[188:191], v5 offset:12288
    v_mfma_f32_16x16x32_bf16 v[56:59], v[132:135], v[168:171], v[56:59]
    v_mfma_f32_16x16x32_bf16 v[60:63], v[132:135], v[172:175], v[60:63]
    ds_read_b64_tr_b16 v[132:133], v7 offset:13312
    ds_read_b64_tr_b16 v[134:135], v7 offset:14080
    v_mfma_f32_16x16x32_bf16 v[64:67], v[136:139], v[160:163], v[64:67]
    v_mfma_f32_16x16x32_bf16 v[68:71], v[136:139], v[164:167], v[68:71]
    v_mfma_f32_16x16x32_bf16 v[72:75], v[136:139], v[168:171], v[72:75]
    v_mfma_f32_16x16x32_bf16 v[76:79], v[136:139], v[172:175], v[76:79]
    ds_read_b64_tr_b16 v[136:137], v8 offset:13312
    ds_read_b64_tr_b16 v[138:139], v8 offset:14080
    v_mfma_f32_16x16x32_bf16 v[80:83], v[140:143], v[160:163], v[80:83]
    v_mfma_f32_16x16x32_bf16 v[84:87], v[140:143], v[164:167], v[84:87]
    v_mfma_f32_16x16x32_bf16 v[88:91], v[140:143], v[168:171], v[88:91]
    v_mfma_f32_16x16x32_bf16 v[92:95], v[140:143], v[172:175], v[92:95]
    ds_read_b64_tr_b16 v[140:141], v9 offset:13312
    ds_read_b64_tr_b16 v[142:143], v9 offset:14080
    s_waitcnt lgkmcnt(12)
    v_mfma_f32_16x16x32_bf16 v[96:99], v[144:147], v[160:163], v[96:99]
    v_mfma_f32_16x16x32_bf16 v[100:103], v[144:147], v[164:167], v[100:103]
    ds_read_b64_tr_b16 v[144:145], v10 offset:13312
    ds_read_b64_tr_b16 v[146:147], v10 offset:14080
    v_mfma_f32_16x16x32_bf16 v[104:107], v[148:151], v[160:163], v[104:107]
    v_mfma_f32_16x16x32_bf16 v[108:111], v[148:151], v[164:167], v[108:111]
    ds_read_b64_tr_b16 v[148:149], v11 offset:13312
    ds_read_b64_tr_b16 v[150:151], v11 offset:14080
    v_mfma_f32_16x16x32_bf16 v[112:115], v[152:155], v[160:163], v[112:115]
    v_mfma_f32_16x16x32_bf16 v[116:119], v[152:155], v[164:167], v[116:119]
    ds_read_b64_tr_b16 v[152:153], v12 offset:13312
    ds_read_b64_tr_b16 v[154:155], v12 offset:14080
    v_mfma_f32_16x16x32_bf16 v[120:123], v[156:159], v[160:163], v[120:123]
    v_mfma_f32_16x16x32_bf16 v[124:127], v[156:159], v[164:167], v[124:127]
    ds_read_b64_tr_b16 v[156:157], v13 offset:13312
    ds_read_b64_tr_b16 v[158:159], v13 offset:14080
    s_waitcnt lgkmcnt(8)
    v_mfma_f32_16x16x32_bf16 v[32:35], v[128:131], v[176:179], v[32:35]
    v_mfma_f32_16x16x32_bf16 v[36:39], v[128:131], v[180:183], v[36:39]
    v_mfma_f32_16x16x32_bf16 v[40:43], v[128:131], v[184:187], v[40:43]
    v_mfma_f32_16x16x32_bf16 v[44:47], v[128:131], v[188:191], v[44:47]
    s_waitcnt lgkmcnt(0)
    s_barrier
    ds_read_b64_tr_b16 v[128:129], v6 offset:20480
    ds_read_b64_tr_b16 v[130:131], v6 offset:21248
    v_mfma_f32_16x16x32_bf16 v[48:51], v[132:135], v[176:179], v[48:51]
    ds_read_b128 v[160:163], v2 offset:20480
    ds_read_b128 v[164:167], v2 offset:22528
    v_mfma_f32_16x16x32_bf16 v[52:55], v[132:135], v[180:183], v[52:55]
    ds_read_b128 v[168:171], v4 offset:20480
    ds_read_b128 v[172:175], v4 offset:22528
    v_mfma_f32_16x16x32_bf16 v[56:59], v[132:135], v[184:187], v[56:59]
    v_mfma_f32_16x16x32_bf16 v[60:63], v[132:135], v[188:191], v[60:63]
    ds_read_b64_tr_b16 v[132:133], v7 offset:20480
    ds_read_b64_tr_b16 v[134:135], v7 offset:21248
    v_mfma_f32_16x16x32_bf16 v[64:67], v[136:139], v[176:179], v[64:67]
    v_mfma_f32_16x16x32_bf16 v[68:71], v[136:139], v[180:183], v[68:71]
    v_mfma_f32_16x16x32_bf16 v[72:75], v[136:139], v[184:187], v[72:75]
    v_mfma_f32_16x16x32_bf16 v[76:79], v[136:139], v[188:191], v[76:79]
    ds_read_b64_tr_b16 v[136:137], v8 offset:20480
    ds_read_b64_tr_b16 v[138:139], v8 offset:21248
    v_mfma_f32_16x16x32_bf16 v[80:83], v[140:143], v[176:179], v[80:83]
    v_mfma_f32_16x16x32_bf16 v[84:87], v[140:143], v[180:183], v[84:87]
    v_mfma_f32_16x16x32_bf16 v[88:91], v[140:143], v[184:187], v[88:91]
    v_mfma_f32_16x16x32_bf16 v[92:95], v[140:143], v[188:191], v[92:95]
    ds_read_b64_tr_b16 v[140:141], v9 offset:20480
    ds_read_b64_tr_b16 v[142:143], v9 offset:21248
    v_mfma_f32_16x16x32_bf16 v[96:99], v[144:147], v[176:179], v[96:99]
    v_mfma_f32_16x16x32_bf16 v[100:103], v[144:147], v[180:183], v[100:103]
    ds_read_b64_tr_b16 v[144:145], v10 offset:20480
    ds_read_b64_tr_b16 v[146:147], v10 offset:21248
    v_mfma_f32_16x16x32_bf16 v[104:107], v[148:151], v[176:179], v[104:107]
    v_mfma_f32_16x16x32_bf16 v[108:111], v[148:151], v[180:183], v[108:111]
    ds_read_b64_tr_b16 v[148:149], v11 offset:20480
    ds_read_b64_tr_b16 v[150:151], v11 offset:21248
    v_mfma_f32_16x16x32_bf16 v[112:115], v[152:155], v[176:179], v[112:115]
    v_mfma_f32_16x16x32_bf16 v[116:119], v[152:155], v[180:183], v[116:119]
    ds_read_b64_tr_b16 v[152:153], v12 offset:20480
    ds_read_b64_tr_b16 v[154:155], v12 offset:21248
    v_mfma_f32_16x16x32_bf16 v[120:123], v[156:159], v[176:179], v[120:123]
    v_mfma_f32_16x16x32_bf16 v[124:127], v[156:159], v[180:183], v[124:127]
    ds_read_b64_tr_b16 v[156:157], v13 offset:20480
    ds_read_b64_tr_b16 v[158:159], v13 offset:21248
    s_waitcnt lgkmcnt(8)
    v_mfma_f32_16x16x32_bf16 v[32:35], v[128:131], v[160:163], v[32:35]
    v_mfma_f32_16x16x32_bf16 v[36:39], v[128:131], v[164:167], v[36:39]
    v_mfma_f32_16x16x32_bf16 v[40:43], v[128:131], v[168:171], v[40:43]
    v_mfma_f32_16x16x32_bf16 v[44:47], v[128:131], v[172:175], v[44:47]
    ds_read_b64_tr_b16 v[128:129], v6 offset:23552
    ds_read_b64_tr_b16 v[130:131], v6 offset:24320
    v_mfma_f32_16x16x32_bf16 v[48:51], v[132:135], v[160:163], v[48:51]
    ds_read_b128 v[176:179], v3 offset:20480
    ds_read_b128 v[180:183], v3 offset:22528
    v_mfma_f32_16x16x32_bf16 v[52:55], v[132:135], v[164:167], v[52:55]
    ds_read_b128 v[184:187], v5 offset:20480
    ds_read_b128 v[188:191], v5 offset:22528
    v_mfma_f32_16x16x32_bf16 v[56:59], v[132:135], v[168:171], v[56:59]
    v_mfma_f32_16x16x32_bf16 v[60:63], v[132:135], v[172:175], v[60:63]
    ds_read_b64_tr_b16 v[132:133], v7 offset:23552
    ds_read_b64_tr_b16 v[134:135], v7 offset:24320
    v_mfma_f32_16x16x32_bf16 v[64:67], v[136:139], v[160:163], v[64:67]
    v_mfma_f32_16x16x32_bf16 v[68:71], v[136:139], v[164:167], v[68:71]
    v_mfma_f32_16x16x32_bf16 v[72:75], v[136:139], v[168:171], v[72:75]
    v_mfma_f32_16x16x32_bf16 v[76:79], v[136:139], v[172:175], v[76:79]
    ds_read_b64_tr_b16 v[136:137], v8 offset:23552
    ds_read_b64_tr_b16 v[138:139], v8 offset:24320
    v_mfma_f32_16x16x32_bf16 v[80:83], v[140:143], v[160:163], v[80:83]
    v_mfma_f32_16x16x32_bf16 v[84:87], v[140:143], v[164:167], v[84:87]
    v_mfma_f32_16x16x32_bf16 v[88:91], v[140:143], v[168:171], v[88:91]
    v_mfma_f32_16x16x32_bf16 v[92:95], v[140:143], v[172:175], v[92:95]
    ds_read_b64_tr_b16 v[140:141], v9 offset:23552
    ds_read_b64_tr_b16 v[142:143], v9 offset:24320
    s_waitcnt lgkmcnt(12)
    v_mfma_f32_16x16x32_bf16 v[96:99], v[144:147], v[160:163], v[96:99]
    v_mfma_f32_16x16x32_bf16 v[100:103], v[144:147], v[164:167], v[100:103]
    ds_read_b64_tr_b16 v[144:145], v10 offset:23552
    ds_read_b64_tr_b16 v[146:147], v10 offset:24320
    v_mfma_f32_16x16x32_bf16 v[104:107], v[148:151], v[160:163], v[104:107]
    v_mfma_f32_16x16x32_bf16 v[108:111], v[148:151], v[164:167], v[108:111]
    ds_read_b64_tr_b16 v[148:149], v11 offset:23552
    ds_read_b64_tr_b16 v[150:151], v11 offset:24320
    v_mfma_f32_16x16x32_bf16 v[112:115], v[152:155], v[160:163], v[112:115]
    v_mfma_f32_16x16x32_bf16 v[116:119], v[152:155], v[164:167], v[116:119]
    ds_read_b64_tr_b16 v[152:153], v12 offset:23552
    ds_read_b64_tr_b16 v[154:155], v12 offset:24320
    v_mfma_f32_16x16x32_bf16 v[120:123], v[156:159], v[160:163], v[120:123]
    v_mfma_f32_16x16x32_bf16 v[124:127], v[156:159], v[164:167], v[124:127]
    ds_read_b64_tr_b16 v[156:157], v13 offset:23552
    ds_read_b64_tr_b16 v[158:159], v13 offset:24320
    s_waitcnt lgkmcnt(8)
    v_mfma_f32_16x16x32_bf16 v[32:35], v[128:131], v[176:179], v[32:35]
    v_mfma_f32_16x16x32_bf16 v[36:39], v[128:131], v[180:183], v[36:39]
    v_mfma_f32_16x16x32_bf16 v[40:43], v[128:131], v[184:187], v[40:43]
    v_mfma_f32_16x16x32_bf16 v[44:47], v[128:131], v[188:191], v[44:47]
    s_waitcnt lgkmcnt(0)
    s_barrier
    ds_read_b64_tr_b16 v[128:129], v6 offset:0
    ds_read_b64_tr_b16 v[130:131], v6 offset:768
    v_mfma_f32_16x16x32_bf16 v[48:51], v[132:135], v[176:179], v[48:51]
    ds_read_b128 v[160:163], v2 offset:0
    ds_read_b128 v[164:167], v2 offset:2048
    v_mfma_f32_16x16x32_bf16 v[52:55], v[132:135], v[180:183], v[52:55]
    ds_read_b128 v[168:171], v4 offset:0
    ds_read_b128 v[172:175], v4 offset:2048
    v_mfma_f32_16x16x32_bf16 v[56:59], v[132:135], v[184:187], v[56:59]
    v_mfma_f32_16x16x32_bf16 v[60:63], v[132:135], v[188:191], v[60:63]
    ds_read_b64_tr_b16 v[132:133], v7 offset:0
    ds_read_b64_tr_b16 v[134:135], v7 offset:768
    v_mfma_f32_16x16x32_bf16 v[64:67], v[136:139], v[176:179], v[64:67]
    v_mfma_f32_16x16x32_bf16 v[68:71], v[136:139], v[180:183], v[68:71]
    v_mfma_f32_16x16x32_bf16 v[72:75], v[136:139], v[184:187], v[72:75]
    v_mfma_f32_16x16x32_bf16 v[76:79], v[136:139], v[188:191], v[76:79]
    ds_read_b64_tr_b16 v[136:137], v8 offset:0
    ds_read_b64_tr_b16 v[138:139], v8 offset:768
    v_mfma_f32_16x16x32_bf16 v[80:83], v[140:143], v[176:179], v[80:83]
    v_mfma_f32_16x16x32_bf16 v[84:87], v[140:143], v[180:183], v[84:87]
    v_mfma_f32_16x16x32_bf16 v[88:91], v[140:143], v[184:187], v[88:91]
    v_mfma_f32_16x16x32_bf16 v[92:95], v[140:143], v[188:191], v[92:95]
    ds_read_b64_tr_b16 v[140:141], v9 offset:0
    ds_read_b64_tr_b16 v[142:143], v9 offset:768
    v_mfma_f32_16x16x32_bf16 v[96:99], v[144:147], v[176:179], v[96:99]
    v_mfma_f32_16x16x32_bf16 v[100:103], v[144:147], v[180:183], v[100:103]
    ds_read_b64_tr_b16 v[144:145], v10 offset:0
    ds_read_b64_tr_b16 v[146:147], v10 offset:768
    v_mfma_f32_16x16x32_bf16 v[104:107], v[148:151], v[176:179], v[104:107]
    v_mfma_f32_16x16x32_bf16 v[108:111], v[148:151], v[180:183], v[108:111]
    ds_read_b64_tr_b16 v[148:149], v11 offset:0
    ds_read_b64_tr_b16 v[150:151], v11 offset:768
    v_mfma_f32_16x16x32_bf16 v[112:115], v[152:155], v[176:179], v[112:115]
    v_mfma_f32_16x16x32_bf16 v[116:119], v[152:155], v[180:183], v[116:119]
    ds_read_b64_tr_b16 v[152:153], v12 offset:0
    ds_read_b64_tr_b16 v[154:155], v12 offset:768
    v_mfma_f32_16x16x32_bf16 v[120:123], v[156:159], v[176:179], v[120:123]
    v_mfma_f32_16x16x32_bf16 v[124:127], v[156:159], v[180:183], v[124:127]
    ds_read_b64_tr_b16 v[156:157], v13 offset:0
    ds_read_b64_tr_b16 v[158:159], v13 offset:768
    s_waitcnt lgkmcnt(8)
    v_mfma_f32_16x16x32_bf16 v[32:35], v[128:131], v[160:163], v[32:35]
    v_mfma_f32_16x16x32_bf16 v[36:39], v[128:131], v[164:167], v[36:39]
    buffer_load_dwordx4 v[192:195], v14, s[44:47], s92 offen offset:0 sc1
    v_mfma_f32_16x16x32_bf16 v[40:43], v[128:131], v[168:171], v[40:43]
    v_mfma_f32_16x16x32_bf16 v[44:47], v[128:131], v[172:175], v[44:47]
    ds_read_b64_tr_b16 v[128:129], v6 offset:3072
    ds_read_b64_tr_b16 v[130:131], v6 offset:3840
    v_mfma_f32_16x16x32_bf16 v[48:51], v[132:135], v[160:163], v[48:51]
    ds_read_b128 v[176:179], v3 offset:0
    ds_read_b128 v[180:183], v3 offset:2048
    v_mfma_f32_16x16x32_bf16 v[52:55], v[132:135], v[164:167], v[52:55]
    ds_read_b128 v[184:187], v5 offset:0
    ds_read_b128 v[188:191], v5 offset:2048
    v_mfma_f32_16x16x32_bf16 v[56:59], v[132:135], v[168:171], v[56:59]
    v_mfma_f32_16x16x32_bf16 v[60:63], v[132:135], v[172:175], v[60:63]
    ds_read_b64_tr_b16 v[132:133], v7 offset:3072
    ds_read_b64_tr_b16 v[134:135], v7 offset:3840
    v_mfma_f32_16x16x32_bf16 v[64:67], v[136:139], v[160:163], v[64:67]
    buffer_load_dwordx4 v[196:199], v14, s[44:47], s93 offen offset:0 sc1
    v_mfma_f32_16x16x32_bf16 v[68:71], v[136:139], v[164:167], v[68:71]
    v_mfma_f32_16x16x32_bf16 v[72:75], v[136:139], v[168:171], v[72:75]
    v_mfma_f32_16x16x32_bf16 v[76:79], v[136:139], v[172:175], v[76:79]
    ds_read_b64_tr_b16 v[136:137], v8 offset:3072
    ds_read_b64_tr_b16 v[138:139], v8 offset:3840
    v_mfma_f32_16x16x32_bf16 v[80:83], v[140:143], v[160:163], v[80:83]
    buffer_load_dwordx4 v[200:203], v14, s[44:47], s94 offen offset:0 sc1
    v_mfma_f32_16x16x32_bf16 v[84:87], v[140:143], v[164:167], v[84:87]
    v_mfma_f32_16x16x32_bf16 v[88:91], v[140:143], v[168:171], v[88:91]
    v_mfma_f32_16x16x32_bf16 v[92:95], v[140:143], v[172:175], v[92:95]
    ds_read_b64_tr_b16 v[140:141], v9 offset:3072
    ds_read_b64_tr_b16 v[142:143], v9 offset:3840
    s_waitcnt lgkmcnt(12)
    v_mfma_f32_16x16x32_bf16 v[96:99], v[144:147], v[160:163], v[96:99]
    buffer_load_dwordx4 v[204:207], v14, s[44:47], s95 offen offset:0 sc1
    v_mfma_f32_16x16x32_bf16 v[100:103], v[144:147], v[164:167], v[100:103]
    ds_read_b64_tr_b16 v[144:145], v10 offset:3072
    ds_read_b64_tr_b16 v[146:147], v10 offset:3840
    v_mfma_f32_16x16x32_bf16 v[104:107], v[148:151], v[160:163], v[104:107]
    v_mfma_f32_16x16x32_bf16 v[108:111], v[148:151], v[164:167], v[108:111]
    ds_read_b64_tr_b16 v[148:149], v11 offset:3072
    ds_read_b64_tr_b16 v[150:151], v11 offset:3840
    v_mfma_f32_16x16x32_bf16 v[112:115], v[152:155], v[160:163], v[112:115]
    v_mfma_f32_16x16x32_bf16 v[116:119], v[152:155], v[164:167], v[116:119]
    ds_read_b64_tr_b16 v[152:153], v12 offset:3072
    ds_read_b64_tr_b16 v[154:155], v12 offset:3840
    v_mfma_f32_16x16x32_bf16 v[120:123], v[156:159], v[160:163], v[120:123]
    v_mfma_f32_16x16x32_bf16 v[124:127], v[156:159], v[164:167], v[124:127]
    ds_read_b64_tr_b16 v[156:157], v13 offset:3072
    ds_read_b64_tr_b16 v[158:159], v13 offset:3840
    s_waitcnt lgkmcnt(8)
    v_mfma_f32_16x16x32_bf16 v[32:35], v[128:131], v[176:179], v[32:35]
    v_mfma_f32_16x16x32_bf16 v[36:39], v[128:131], v[180:183], v[36:39]
    buffer_load_dwordx4 v[208:211], v14, s[44:47], s92 offen offset:1024 sc1
    v_mfma_f32_16x16x32_bf16 v[40:43], v[128:131], v[184:187], v[40:43]
    v_mfma_f32_16x16x32_bf16 v[44:47], v[128:131], v[188:191], v[44:47]
    s_waitcnt lgkmcnt(0)
    s_barrier
    ds_read_b64_tr_b16 v[128:129], v6 offset:10240
    ds_read_b64_tr_b16 v[130:131], v6 offset:11008
    v_mfma_f32_16x16x32_bf16 v[48:51], v[132:135], v[176:179], v[48:51]
    ds_read_b128 v[160:163], v2 offset:10240
    ds_read_b128 v[164:167], v2 offset:12288
    v_mfma_f32_16x16x32_bf16 v[52:55], v[132:135], v[180:183], v[52:55]
    ds_read_b128 v[168:171], v4 offset:10240
    ds_read_b128 v[172:175], v4 offset:12288
    v_mfma_f32_16x16x32_bf16 v[56:59], v[132:135], v[184:187], v[56:59]
    v_mfma_f32_16x16x32_bf16 v[60:63], v[132:135], v[188:191], v[60:63]
    ds_read_b64_tr_b16 v[132:133], v7 offset:10240
    ds_read_b64_tr_b16 v[134:135], v7 offset:11008
    v_mfma_f32_16x16x32_bf16 v[64:67], v[136:139], v[176:179], v[64:67]
    buffer_load_dwordx4 v[212:215], v14, s[44:47], s93 offen offset:1024 sc1
    v_mfma_f32_16x16x32_bf16 v[68:71], v[136:139], v[180:183], v[68:71]
    v_mfma_f32_16x16x32_bf16 v[72:75], v[136:139], v[184:187], v[72:75]
    v_mfma_f32_16x16x32_bf16 v[76:79], v[136:139], v[188:191], v[76:79]
    ds_read_b64_tr_b16 v[136:137], v8 offset:10240
    ds_read_b64_tr_b16 v[138:139], v8 offset:11008
    v_mfma_f32_16x16x32_bf16 v[80:83], v[140:143], v[176:179], v[80:83]
    buffer_load_dwordx4 v[216:219], v14, s[44:47], s94 offen offset:1024 sc1
    v_mfma_f32_16x16x32_bf16 v[84:87], v[140:143], v[180:183], v[84:87]
    v_mfma_f32_16x16x32_bf16 v[88:91], v[140:143], v[184:187], v[88:91]
    v_mfma_f32_16x16x32_bf16 v[92:95], v[140:143], v[188:191], v[92:95]
    ds_read_b64_tr_b16 v[140:141], v9 offset:10240
    ds_read_b64_tr_b16 v[142:143], v9 offset:11008
    v_mfma_f32_16x16x32_bf16 v[96:99], v[144:147], v[176:179], v[96:99]
    buffer_load_dwordx4 v[220:223], v14, s[44:47], s95 offen offset:1024 sc1
    v_mfma_f32_16x16x32_bf16 v[100:103], v[144:147], v[180:183], v[100:103]
    ds_read_b64_tr_b16 v[144:145], v10 offset:10240
    ds_read_b64_tr_b16 v[146:147], v10 offset:11008
    v_mfma_f32_16x16x32_bf16 v[104:107], v[148:151], v[176:179], v[104:107]
    v_mfma_f32_16x16x32_bf16 v[108:111], v[148:151], v[180:183], v[108:111]
    ds_read_b64_tr_b16 v[148:149], v11 offset:10240
    ds_read_b64_tr_b16 v[150:151], v11 offset:11008
    v_mfma_f32_16x16x32_bf16 v[112:115], v[152:155], v[176:179], v[112:115]
    v_mfma_f32_16x16x32_bf16 v[116:119], v[152:155], v[180:183], v[116:119]
    ds_read_b64_tr_b16 v[152:153], v12 offset:10240
    ds_read_b64_tr_b16 v[154:155], v12 offset:11008
    v_mfma_f32_16x16x32_bf16 v[120:123], v[156:159], v[176:179], v[120:123]
    v_mfma_f32_16x16x32_bf16 v[124:127], v[156:159], v[180:183], v[124:127]
    ds_read_b64_tr_b16 v[156:157], v13 offset:10240
    ds_read_b64_tr_b16 v[158:159], v13 offset:11008
    s_waitcnt lgkmcnt(8)
    v_mfma_f32_16x16x32_bf16 v[32:35], v[128:131], v[160:163], v[32:35]
    v_mfma_f32_16x16x32_bf16 v[36:39], v[128:131], v[164:167], v[36:39]
    buffer_load_dwordx4 v[224:227], v14, s[44:47], s92 offen offset:2048 sc1
    v_mfma_f32_16x16x32_bf16 v[40:43], v[128:131], v[168:171], v[40:43]
    v_mfma_f32_16x16x32_bf16 v[44:47], v[128:131], v[172:175], v[44:47]
    ds_read_b64_tr_b16 v[128:129], v6 offset:13312
    ds_read_b64_tr_b16 v[130:131], v6 offset:14080
    v_mfma_f32_16x16x32_bf16 v[48:51], v[132:135], v[160:163], v[48:51]
    ds_read_b128 v[176:179], v3 offset:10240
    ds_read_b128 v[180:183], v3 offset:12288
    v_mfma_f32_16x16x32_bf16 v[52:55], v[132:135], v[164:167], v[52:55]
    ds_read_b128 v[184:187], v5 offset:10240
    ds_read_b128 v[188:191], v5 offset:12288
    v_mfma_f32_16x16x32_bf16 v[56:59], v[132:135], v[168:171], v[56:59]
    v_mfma_f32_16x16x32_bf16 v[60:63], v[132:135], v[172:175], v[60:63]
    ds_read_b64_tr_b16 v[132:133], v7 offset:13312
    ds_read_b64_tr_b16 v[134:135], v7 offset:14080
    v_mfma_f32_16x16x32_bf16 v[64:67], v[136:139], v[160:163], v[64:67]
    buffer_load_dwordx4 v[228:231], v14, s[44:47], s93 offen offset:2048 sc1
    v_mfma_f32_16x16x32_bf16 v[68:71], v[136:139], v[164:167], v[68:71]
    v_mfma_f32_16x16x32_bf16 v[72:75], v[136:139], v[168:171], v[72:75]
    v_mfma_f32_16x16x32_bf16 v[76:79], v[136:139], v[172:175], v[76:79]
    ds_read_b64_tr_b16 v[136:137], v8 offset:13312
    ds_read_b64_tr_b16 v[138:139], v8 offset:14080
    v_mfma_f32_16x16x32_bf16 v[80:83], v[140:143], v[160:163], v[80:83]
    buffer_load_dwordx4 v[232:235], v14, s[44:47], s94 offen offset:2048 sc1
    v_mfma_f32_16x16x32_bf16 v[84:87], v[140:143], v[164:167], v[84:87]
    v_mfma_f32_16x16x32_bf16 v[88:91], v[140:143], v[168:171], v[88:91]
    v_mfma_f32_16x16x32_bf16 v[92:95], v[140:143], v[172:175], v[92:95]
    ds_read_b64_tr_b16 v[140:141], v9 offset:13312
    ds_read_b64_tr_b16 v[142:143], v9 offset:14080
    s_waitcnt lgkmcnt(12)
    v_mfma_f32_16x16x32_bf16 v[96:99], v[144:147], v[160:163], v[96:99]
    buffer_load_dwordx4 v[236:239], v14, s[44:47], s95 offen offset:2048 sc1
    v_mfma_f32_16x16x32_bf16 v[100:103], v[144:147], v[164:167], v[100:103]
    ds_read_b64_tr_b16 v[144:145], v10 offset:13312
    ds_read_b64_tr_b16 v[146:147], v10 offset:14080
    v_mfma_f32_16x16x32_bf16 v[104:107], v[148:151], v[160:163], v[104:107]
    v_mfma_f32_16x16x32_bf16 v[108:111], v[148:151], v[164:167], v[108:111]
    ds_read_b64_tr_b16 v[148:149], v11 offset:13312
    ds_read_b64_tr_b16 v[150:151], v11 offset:14080
    v_mfma_f32_16x16x32_bf16 v[112:115], v[152:155], v[160:163], v[112:115]
    v_mfma_f32_16x16x32_bf16 v[116:119], v[152:155], v[164:167], v[116:119]
    ds_read_b64_tr_b16 v[152:153], v12 offset:13312
    ds_read_b64_tr_b16 v[154:155], v12 offset:14080
    v_mfma_f32_16x16x32_bf16 v[120:123], v[156:159], v[160:163], v[120:123]
    v_mfma_f32_16x16x32_bf16 v[124:127], v[156:159], v[164:167], v[124:127]
    ds_read_b64_tr_b16 v[156:157], v13 offset:13312
    ds_read_b64_tr_b16 v[158:159], v13 offset:14080
    s_waitcnt lgkmcnt(8)
    v_mfma_f32_16x16x32_bf16 v[32:35], v[128:131], v[176:179], v[32:35]
    v_mfma_f32_16x16x32_bf16 v[36:39], v[128:131], v[180:183], v[36:39]
    buffer_load_dwordx4 v[240:243], v14, s[44:47], s92 offen offset:3072 sc1
    v_mfma_f32_16x16x32_bf16 v[40:43], v[128:131], v[184:187], v[40:43]
    v_mfma_f32_16x16x32_bf16 v[44:47], v[128:131], v[188:191], v[44:47]
    v_mfma_f32_16x16x32_bf16 v[48:51], v[132:135], v[176:179], v[48:51]
    buffer_load_dwordx4 v[244:247], v14, s[44:47], s93 offen offset:3072 sc1
    v_mfma_f32_16x16x32_bf16 v[52:55], v[132:135], v[180:183], v[52:55]
    v_mfma_f32_16x16x32_bf16 v[56:59], v[132:135], v[184:187], v[56:59]
    v_mfma_f32_16x16x32_bf16 v[60:63], v[132:135], v[188:191], v[60:63]
    buffer_load_dwordx4 v[248:251], v14, s[44:47], s94 offen offset:3072 sc1
    v_mfma_f32_16x16x32_bf16 v[64:67], v[136:139], v[176:179], v[64:67]
    v_mfma_f32_16x16x32_bf16 v[68:71], v[136:139], v[180:183], v[68:71]
    v_mfma_f32_16x16x32_bf16 v[72:75], v[136:139], v[184:187], v[72:75]
    buffer_load_dwordx4 v[252:255], v14, s[44:47], s95 offen offset:3072 sc1
    v_mfma_f32_16x16x32_bf16 v[76:79], v[136:139], v[188:191], v[76:79]
    v_mfma_f32_16x16x32_bf16 v[80:83], v[140:143], v[176:179], v[80:83]
    v_mfma_f32_16x16x32_bf16 v[84:87], v[140:143], v[180:183], v[84:87]
    v_mfma_f32_16x16x32_bf16 v[88:91], v[140:143], v[184:187], v[88:91]
    s_waitcnt lgkmcnt(0)
    s_barrier
    ds_read_b128 v[160:163], v22 offset:40192
    ds_read_b128 v[164:167], v22 offset:40448
    v_mfma_f32_16x16x32_bf16 v[92:95], v[140:143], v[188:191], v[92:95]
    ds_read_b128 v[168:171], v23 offset:40192
    ds_read_b128 v[172:175], v23 offset:40448
    v_mfma_f32_16x16x32_bf16 v[96:99], v[144:147], v[176:179], v[96:99]
    ds_read_b128 v[128:131], v21 offset:0
    ds_read_b128 v[132:135], v21 offset:64
    v_mfma_f32_16x16x32_bf16 v[100:103], v[144:147], v[180:183], v[100:103]
    ds_read_b128 v[136:139], v21 offset:128
    ds_read_b128 v[140:143], v21 offset:192
    v_mfma_f32_16x16x32_bf16 v[104:107], v[148:151], v[176:179], v[104:107]
    v_mfma_f32_16x16x32_bf16 v[108:111], v[148:151], v[180:183], v[108:111]
    v_mfma_f32_16x16x32_bf16 v[112:115], v[152:155], v[176:179], v[112:115]
    v_mfma_f32_16x16x32_bf16 v[116:119], v[152:155], v[180:183], v[116:119]
    v_mfma_f32_16x16x32_bf16 v[120:123], v[156:159], v[176:179], v[120:123]
    v_mfma_f32_16x16x32_bf16 v[124:127], v[156:159], v[180:183], v[124:127]
    ds_read_b128 v[144:147], v20 offset:512
    ds_read_b128 v[148:151], v20 offset:576
    ds_read_b128 v[152:155], v20 offset:640
    ds_read_b128 v[156:159], v20 offset:704
    s_waitcnt lgkmcnt(4)
    v_pk_fma_f32 v[32:33], v[128:129], v[160:161], v[32:33] op_sel_hi:[1,0,1]
    v_pk_fma_f32 v[34:35], v[130:131], v[160:161], v[34:35] op_sel_hi:[1,0,1]
    v_pk_fma_f32 v[64:65], v[136:137], v[160:161], v[64:65] op_sel_hi:[1,0,1]
    v_pk_fma_f32 v[66:67], v[138:139], v[160:161], v[66:67] op_sel_hi:[1,0,1]
    v_pk_mul_f32 v[176:177], v[32:33], v[32:33]
    v_pk_mul_f32 v[178:179], v[34:35], v[34:35]
    v_pk_mul_f32 v[180:181], v[64:65], v[64:65]
    v_pk_mul_f32 v[182:183], v[66:67], v[66:67]
    v_pk_fma_f32 v[176:177], v[176:177], v[162:163], v[162:163] op_sel:[0,1,0] op_sel_hi:[1,1,0]
    v_pk_fma_f32 v[178:179], v[178:179], v[162:163], v[162:163] op_sel:[0,1,0] op_sel_hi:[1,1,0]
    v_pk_fma_f32 v[180:181], v[180:181], v[162:163], v[162:163] op_sel:[0,1,0] op_sel_hi:[1,1,0]
    v_pk_fma_f32 v[182:183], v[182:183], v[162:163], v[162:163] op_sel:[0,1,0] op_sel_hi:[1,1,0]
    v_pk_mul_f32 v[176:177], v[176:177], v[32:33]
    v_pk_mul_f32 v[178:179], v[178:179], v[34:35]
    v_pk_mul_f32 v[180:181], v[180:181], v[64:65]
    v_pk_mul_f32 v[182:183], v[182:183], v[66:67]
    v_exp_f32 v176, v176
    v_exp_f32 v177, v177
    v_exp_f32 v178, v178
    v_exp_f32 v179, v179
    v_exp_f32 v180, v180
    v_exp_f32 v181, v181
    v_exp_f32 v182, v182
    v_exp_f32 v183, v183
    v_pk_fma_f32 v[48:49], v[132:133], v[160:161], v[48:49] op_sel_hi:[1,0,1]
    v_pk_fma_f32 v[50:51], v[134:135], v[160:161], v[50:51] op_sel_hi:[1,0,1]
    v_pk_fma_f32 v[80:81], v[140:141], v[160:161], v[80:81] op_sel_hi:[1,0,1]
    v_pk_fma_f32 v[82:83], v[142:143], v[160:161], v[82:83] op_sel_hi:[1,0,1]
    v_pk_fma_f32 v[176:177], v[176:177], v[160:161], v[160:161] op_sel:[0,1,1] op_sel_hi:[1,1,1]
    v_pk_fma_f32 v[178:179], v[178:179], v[160:161], v[160:161] op_sel:[0,1,1] op_sel_hi:[1,1,1]
    v_pk_fma_f32 v[180:181], v[180:181], v[160:161], v[160:161] op_sel:[0,1,1] op_sel_hi:[1,1,1]
    v_pk_fma_f32 v[182:183], v[182:183], v[160:161], v[160:161] op_sel:[0,1,1] op_sel_hi:[1,1,1]
    v_rcp_f32 v176, v176
    v_rcp_f32 v177, v177
    v_rcp_f32 v178, v178
    v_rcp_f32 v179, v179
    v_rcp_f32 v180, v180
    v_rcp_f32 v181, v181
    v_rcp_f32 v182, v182
    v_rcp_f32 v183, v183
    v_pk_mul_f32 v[32:33], v[32:33], v[48:49]
    v_pk_mul_f32 v[34:35], v[34:35], v[50:51]
    v_pk_mul_f32 v[64:65], v[64:65], v[80:81]
    v_pk_mul_f32 v[66:67], v[66:67], v[82:83]
    v_pk_mul_f32 v[32:33], v[32:33], v[176:177]
    v_pk_mul_f32 v[34:35], v[34:35], v[178:179]
    v_pk_mul_f32 v[64:65], v[64:65], v[180:181]
    v_pk_mul_f32 v[66:67], v[66:67], v[182:183]
    v_cvt_pk_bf16_f32 v184, v32, v33
    v_cvt_pk_bf16_f32 v185, v34, v35
    v_cvt_pk_bf16_f32 v186, v64, v65
    v_cvt_pk_bf16_f32 v187, v66, v67
    buffer_store_dwordx4 v[184:187], v14, s[44:47], s83 offen sc1
    v_pk_fma_f32 v[36:37], v[128:129], v[164:165], v[36:37] op_sel_hi:[1,0,1]
    v_pk_fma_f32 v[38:39], v[130:131], v[164:165], v[38:39] op_sel_hi:[1,0,1]
    v_pk_fma_f32 v[68:69], v[136:137], v[164:165], v[68:69] op_sel_hi:[1,0,1]
    v_pk_fma_f32 v[70:71], v[138:139], v[164:165], v[70:71] op_sel_hi:[1,0,1]
    v_pk_mul_f32 v[176:177], v[36:37], v[36:37]
    v_pk_mul_f32 v[178:179], v[38:39], v[38:39]
    v_pk_mul_f32 v[180:181], v[68:69], v[68:69]
    v_pk_mul_f32 v[182:183], v[70:71], v[70:71]
    v_pk_fma_f32 v[176:177], v[176:177], v[166:167], v[166:167] op_sel:[0,1,0] op_sel_hi:[1,1,0]
    v_pk_fma_f32 v[178:179], v[178:179], v[166:167], v[166:167] op_sel:[0,1,0] op_sel_hi:[1,1,0]
    v_pk_fma_f32 v[180:181], v[180:181], v[166:167], v[166:167] op_sel:[0,1,0] op_sel_hi:[1,1,0]
    v_pk_fma_f32 v[182:183], v[182:183], v[166:167], v[166:167] op_sel:[0,1,0] op_sel_hi:[1,1,0]
    v_pk_mul_f32 v[176:177], v[176:177], v[36:37]
    v_pk_mul_f32 v[178:179], v[178:179], v[38:39]
    v_pk_mul_f32 v[180:181], v[180:181], v[68:69]
    v_pk_mul_f32 v[182:183], v[182:183], v[70:71]
    v_exp_f32 v176, v176
    v_exp_f32 v177, v177
    v_exp_f32 v178, v178
    v_exp_f32 v179, v179
    v_exp_f32 v180, v180
    v_exp_f32 v181, v181
    v_exp_f32 v182, v182
    v_exp_f32 v183, v183
    v_pk_fma_f32 v[52:53], v[132:133], v[164:165], v[52:53] op_sel_hi:[1,0,1]
    v_pk_fma_f32 v[54:55], v[134:135], v[164:165], v[54:55] op_sel_hi:[1,0,1]
    v_pk_fma_f32 v[84:85], v[140:141], v[164:165], v[84:85] op_sel_hi:[1,0,1]
    v_pk_fma_f32 v[86:87], v[142:143], v[164:165], v[86:87] op_sel_hi:[1,0,1]
    v_pk_fma_f32 v[176:177], v[176:177], v[164:165], v[164:165] op_sel:[0,1,1] op_sel_hi:[1,1,1]
    v_pk_fma_f32 v[178:179], v[178:179], v[164:165], v[164:165] op_sel:[0,1,1] op_sel_hi:[1,1,1]
    v_pk_fma_f32 v[180:181], v[180:181], v[164:165], v[164:165] op_sel:[0,1,1] op_sel_hi:[1,1,1]
    v_pk_fma_f32 v[182:183], v[182:183], v[164:165], v[164:165] op_sel:[0,1,1] op_sel_hi:[1,1,1]
    v_rcp_f32 v176, v176
    v_rcp_f32 v177, v177
    v_rcp_f32 v178, v178
    v_rcp_f32 v179, v179
    v_rcp_f32 v180, v180
    v_rcp_f32 v181, v181
    v_rcp_f32 v182, v182
    v_rcp_f32 v183, v183
    v_pk_mul_f32 v[36:37], v[36:37], v[52:53]
    v_pk_mul_f32 v[38:39], v[38:39], v[54:55]
    v_pk_mul_f32 v[68:69], v[68:69], v[84:85]
    v_pk_mul_f32 v[70:71], v[70:71], v[86:87]
    v_pk_mul_f32 v[36:37], v[36:37], v[176:177]
    v_pk_mul_f32 v[38:39], v[38:39], v[178:179]
    v_pk_mul_f32 v[68:69], v[68:69], v[180:181]
    v_pk_mul_f32 v[70:71], v[70:71], v[182:183]
    v_cvt_pk_bf16_f32 v188, v36, v37
    v_cvt_pk_bf16_f32 v189, v38, v39
    v_cvt_pk_bf16_f32 v190, v68, v69
    v_cvt_pk_bf16_f32 v191, v70, v71
    buffer_store_dwordx4 v[188:191], v15, s[44:47], s83 offen sc1
    v_pk_fma_f32 v[40:41], v[128:129], v[168:169], v[40:41] op_sel_hi:[1,0,1]
    v_pk_fma_f32 v[42:43], v[130:131], v[168:169], v[42:43] op_sel_hi:[1,0,1]
    v_pk_fma_f32 v[72:73], v[136:137], v[168:169], v[72:73] op_sel_hi:[1,0,1]
    v_pk_fma_f32 v[74:75], v[138:139], v[168:169], v[74:75] op_sel_hi:[1,0,1]
    v_pk_mul_f32 v[176:177], v[40:41], v[40:41]
    v_pk_mul_f32 v[178:179], v[42:43], v[42:43]
    v_pk_mul_f32 v[180:181], v[72:73], v[72:73]
    v_pk_mul_f32 v[182:183], v[74:75], v[74:75]
    v_pk_fma_f32 v[176:177], v[176:177], v[170:171], v[170:171] op_sel:[0,1,0] op_sel_hi:[1,1,0]
    v_pk_fma_f32 v[178:179], v[178:179], v[170:171], v[170:171] op_sel:[0,1,0] op_sel_hi:[1,1,0]
    v_pk_fma_f32 v[180:181], v[180:181], v[170:171], v[170:171] op_sel:[0,1,0] op_sel_hi:[1,1,0]
    v_pk_fma_f32 v[182:183], v[182:183], v[170:171], v[170:171] op_sel:[0,1,0] op_sel_hi:[1,1,0]
    v_pk_mul_f32 v[176:177], v[176:177], v[40:41]
    v_pk_mul_f32 v[178:179], v[178:179], v[42:43]
    v_pk_mul_f32 v[180:181], v[180:181], v[72:73]
    v_pk_mul_f32 v[182:183], v[182:183], v[74:75]
    v_exp_f32 v176, v176
    v_exp_f32 v177, v177
    v_exp_f32 v178, v178
    v_exp_f32 v179, v179
    v_exp_f32 v180, v180
    v_exp_f32 v181, v181
    v_exp_f32 v182, v182
    v_exp_f32 v183, v183
    v_pk_fma_f32 v[56:57], v[132:133], v[168:169], v[56:57] op_sel_hi:[1,0,1]
    v_pk_fma_f32 v[58:59], v[134:135], v[168:169], v[58:59] op_sel_hi:[1,0,1]
    v_pk_fma_f32 v[88:89], v[140:141], v[168:169], v[88:89] op_sel_hi:[1,0,1]
    v_pk_fma_f32 v[90:91], v[142:143], v[168:169], v[90:91] op_sel_hi:[1,0,1]
    v_pk_fma_f32 v[176:177], v[176:177], v[168:169], v[168:169] op_sel:[0,1,1] op_sel_hi:[1,1,1]
    v_pk_fma_f32 v[178:179], v[178:179], v[168:169], v[168:169] op_sel:[0,1,1] op_sel_hi:[1,1,1]
    v_pk_fma_f32 v[180:181], v[180:181], v[168:169], v[168:169] op_sel:[0,1,1] op_sel_hi:[1,1,1]
    v_pk_fma_f32 v[182:183], v[182:183], v[168:169], v[168:169] op_sel:[0,1,1] op_sel_hi:[1,1,1]
    v_rcp_f32 v176, v176
    v_rcp_f32 v177, v177
    v_rcp_f32 v178, v178
    v_rcp_f32 v179, v179
    v_rcp_f32 v180, v180
    v_rcp_f32 v181, v181
    v_rcp_f32 v182, v182
    v_rcp_f32 v183, v183
    v_pk_mul_f32 v[40:41], v[40:41], v[56:57]
    v_pk_mul_f32 v[42:43], v[42:43], v[58:59]
    v_pk_mul_f32 v[72:73], v[72:73], v[88:89]
    v_pk_mul_f32 v[74:75], v[74:75], v[90:91]
    v_pk_mul_f32 v[40:41], v[40:41], v[176:177]
    v_pk_mul_f32 v[42:43], v[42:43], v[178:179]
    v_pk_mul_f32 v[72:73], v[72:73], v[180:181]
    v_pk_mul_f32 v[74:75], v[74:75], v[182:183]
    v_cvt_pk_bf16_f32 v184, v40, v41
    v_cvt_pk_bf16_f32 v185, v42, v43
    v_cvt_pk_bf16_f32 v186, v72, v73
    v_cvt_pk_bf16_f32 v187, v74, v75
    buffer_store_dwordx4 v[184:187], v14, s[44:47], s84 offen sc1
    v_pk_fma_f32 v[44:45], v[128:129], v[172:173], v[44:45] op_sel_hi:[1,0,1]
    v_pk_fma_f32 v[46:47], v[130:131], v[172:173], v[46:47] op_sel_hi:[1,0,1]
    v_pk_fma_f32 v[76:77], v[136:137], v[172:173], v[76:77] op_sel_hi:[1,0,1]
    v_pk_fma_f32 v[78:79], v[138:139], v[172:173], v[78:79] op_sel_hi:[1,0,1]
    v_pk_mul_f32 v[176:177], v[44:45], v[44:45]
    v_pk_mul_f32 v[178:179], v[46:47], v[46:47]
    v_pk_mul_f32 v[180:181], v[76:77], v[76:77]
    v_pk_mul_f32 v[182:183], v[78:79], v[78:79]
    v_pk_fma_f32 v[176:177], v[176:177], v[174:175], v[174:175] op_sel:[0,1,0] op_sel_hi:[1,1,0]
    v_pk_fma_f32 v[178:179], v[178:179], v[174:175], v[174:175] op_sel:[0,1,0] op_sel_hi:[1,1,0]
    v_pk_fma_f32 v[180:181], v[180:181], v[174:175], v[174:175] op_sel:[0,1,0] op_sel_hi:[1,1,0]
    v_pk_fma_f32 v[182:183], v[182:183], v[174:175], v[174:175] op_sel:[0,1,0] op_sel_hi:[1,1,0]
    v_pk_mul_f32 v[176:177], v[176:177], v[44:45]
    v_pk_mul_f32 v[178:179], v[178:179], v[46:47]
    v_pk_mul_f32 v[180:181], v[180:181], v[76:77]
    v_pk_mul_f32 v[182:183], v[182:183], v[78:79]
    v_exp_f32 v176, v176
    v_exp_f32 v177, v177
    v_exp_f32 v178, v178
    v_exp_f32 v179, v179
    v_exp_f32 v180, v180
    v_exp_f32 v181, v181
    v_exp_f32 v182, v182
    v_exp_f32 v183, v183
    v_pk_fma_f32 v[60:61], v[132:133], v[172:173], v[60:61] op_sel_hi:[1,0,1]
    v_pk_fma_f32 v[62:63], v[134:135], v[172:173], v[62:63] op_sel_hi:[1,0,1]
    v_pk_fma_f32 v[92:93], v[140:141], v[172:173], v[92:93] op_sel_hi:[1,0,1]
    v_pk_fma_f32 v[94:95], v[142:143], v[172:173], v[94:95] op_sel_hi:[1,0,1]
    v_pk_fma_f32 v[176:177], v[176:177], v[172:173], v[172:173] op_sel:[0,1,1] op_sel_hi:[1,1,1]
    v_pk_fma_f32 v[178:179], v[178:179], v[172:173], v[172:173] op_sel:[0,1,1] op_sel_hi:[1,1,1]
    v_pk_fma_f32 v[180:181], v[180:181], v[172:173], v[172:173] op_sel:[0,1,1] op_sel_hi:[1,1,1]
    v_pk_fma_f32 v[182:183], v[182:183], v[172:173], v[172:173] op_sel:[0,1,1] op_sel_hi:[1,1,1]
    v_rcp_f32 v176, v176
    v_rcp_f32 v177, v177
    v_rcp_f32 v178, v178
    v_rcp_f32 v179, v179
    v_rcp_f32 v180, v180
    v_rcp_f32 v181, v181
    v_rcp_f32 v182, v182
    v_rcp_f32 v183, v183
    v_pk_mul_f32 v[44:45], v[44:45], v[60:61]
    v_pk_mul_f32 v[46:47], v[46:47], v[62:63]
    v_pk_mul_f32 v[76:77], v[76:77], v[92:93]
    v_pk_mul_f32 v[78:79], v[78:79], v[94:95]
    v_pk_mul_f32 v[44:45], v[44:45], v[176:177]
    v_pk_mul_f32 v[46:47], v[46:47], v[178:179]
    v_pk_mul_f32 v[76:77], v[76:77], v[180:181]
    v_pk_mul_f32 v[78:79], v[78:79], v[182:183]
    v_cvt_pk_bf16_f32 v188, v44, v45
    v_cvt_pk_bf16_f32 v189, v46, v47
    v_cvt_pk_bf16_f32 v190, v76, v77
    v_cvt_pk_bf16_f32 v191, v78, v79
    buffer_store_dwordx4 v[188:191], v15, s[44:47], s84 offen sc1
    s_waitcnt lgkmcnt(0)
    v_pk_fma_f32 v[96:97], v[144:145], v[160:161], v[96:97] op_sel_hi:[1,0,1]
    v_pk_fma_f32 v[98:99], v[146:147], v[160:161], v[98:99] op_sel_hi:[1,0,1]
    v_pk_fma_f32 v[112:113], v[152:153], v[160:161], v[112:113] op_sel_hi:[1,0,1]
    v_pk_fma_f32 v[114:115], v[154:155], v[160:161], v[114:115] op_sel_hi:[1,0,1]
    v_pk_mul_f32 v[176:177], v[96:97], v[96:97]
    v_pk_mul_f32 v[178:179], v[98:99], v[98:99]
    v_pk_mul_f32 v[180:181], v[112:113], v[112:113]
    v_pk_mul_f32 v[182:183], v[114:115], v[114:115]
    v_pk_fma_f32 v[176:177], v[176:177], v[162:163], v[162:163] op_sel:[0,1,0] op_sel_hi:[1,1,0]
    v_pk_fma_f32 v[178:179], v[178:179], v[162:163], v[162:163] op_sel:[0,1,0] op_sel_hi:[1,1,0]
    v_pk_fma_f32 v[180:181], v[180:181], v[162:163], v[162:163] op_sel:[0,1,0] op_sel_hi:[1,1,0]
    v_pk_fma_f32 v[182:183], v[182:183], v[162:163], v[162:163] op_sel:[0,1,0] op_sel_hi:[1,1,0]
    v_pk_mul_f32 v[176:177], v[176:177], v[96:97]
    v_pk_mul_f32 v[178:179], v[178:179], v[98:99]
    v_pk_mul_f32 v[180:181], v[180:181], v[112:113]
    v_pk_mul_f32 v[182:183], v[182:183], v[114:115]
    v_exp_f32 v176, v176
    v_exp_f32 v177, v177
    v_exp_f32 v178, v178
    v_exp_f32 v179, v179
    v_exp_f32 v180, v180
    v_exp_f32 v181, v181
    v_exp_f32 v182, v182
    v_exp_f32 v183, v183
    v_pk_fma_f32 v[104:105], v[148:149], v[160:161], v[104:105] op_sel_hi:[1,0,1]
    v_pk_fma_f32 v[106:107], v[150:151], v[160:161], v[106:107] op_sel_hi:[1,0,1]
    v_pk_fma_f32 v[120:121], v[156:157], v[160:161], v[120:121] op_sel_hi:[1,0,1]
    v_pk_fma_f32 v[122:123], v[158:159], v[160:161], v[122:123] op_sel_hi:[1,0,1]
    v_pk_fma_f32 v[176:177], v[176:177], v[160:161], v[160:161] op_sel:[0,1,1] op_sel_hi:[1,1,1]
    v_pk_fma_f32 v[178:179], v[178:179], v[160:161], v[160:161] op_sel:[0,1,1] op_sel_hi:[1,1,1]
    v_pk_fma_f32 v[180:181], v[180:181], v[160:161], v[160:161] op_sel:[0,1,1] op_sel_hi:[1,1,1]
    v_pk_fma_f32 v[182:183], v[182:183], v[160:161], v[160:161] op_sel:[0,1,1] op_sel_hi:[1,1,1]
    v_rcp_f32 v176, v176
    v_rcp_f32 v177, v177
    v_rcp_f32 v178, v178
    v_rcp_f32 v179, v179
    v_rcp_f32 v180, v180
    v_rcp_f32 v181, v181
    v_rcp_f32 v182, v182
    v_rcp_f32 v183, v183
    v_pk_mul_f32 v[96:97], v[96:97], v[104:105]
    v_pk_mul_f32 v[98:99], v[98:99], v[106:107]
    v_pk_mul_f32 v[112:113], v[112:113], v[120:121]
    v_pk_mul_f32 v[114:115], v[114:115], v[122:123]
    v_pk_mul_f32 v[96:97], v[96:97], v[176:177]
    v_pk_mul_f32 v[98:99], v[98:99], v[178:179]
    v_pk_mul_f32 v[112:113], v[112:113], v[180:181]
    v_pk_mul_f32 v[114:115], v[114:115], v[182:183]
    v_cvt_pk_bf16_f32 v184, v96, v97
    v_cvt_pk_bf16_f32 v185, v98, v99
    v_cvt_pk_bf16_f32 v186, v112, v113
    v_cvt_pk_bf16_f32 v187, v114, v115
    buffer_store_dwordx4 v[184:187], v14, s[44:47], s85 offen sc1
    v_pk_fma_f32 v[100:101], v[144:145], v[164:165], v[100:101] op_sel_hi:[1,0,1]
    v_pk_fma_f32 v[102:103], v[146:147], v[164:165], v[102:103] op_sel_hi:[1,0,1]
    v_pk_fma_f32 v[116:117], v[152:153], v[164:165], v[116:117] op_sel_hi:[1,0,1]
    v_pk_fma_f32 v[118:119], v[154:155], v[164:165], v[118:119] op_sel_hi:[1,0,1]
    v_pk_mul_f32 v[176:177], v[100:101], v[100:101]
    v_pk_mul_f32 v[178:179], v[102:103], v[102:103]
    v_pk_mul_f32 v[180:181], v[116:117], v[116:117]
    v_pk_mul_f32 v[182:183], v[118:119], v[118:119]
    v_pk_fma_f32 v[176:177], v[176:177], v[166:167], v[166:167] op_sel:[0,1,0] op_sel_hi:[1,1,0]
    v_pk_fma_f32 v[178:179], v[178:179], v[166:167], v[166:167] op_sel:[0,1,0] op_sel_hi:[1,1,0]
    v_pk_fma_f32 v[180:181], v[180:181], v[166:167], v[166:167] op_sel:[0,1,0] op_sel_hi:[1,1,0]
    v_pk_fma_f32 v[182:183], v[182:183], v[166:167], v[166:167] op_sel:[0,1,0] op_sel_hi:[1,1,0]
    v_pk_mul_f32 v[176:177], v[176:177], v[100:101]
    v_pk_mul_f32 v[178:179], v[178:179], v[102:103]
    v_pk_mul_f32 v[180:181], v[180:181], v[116:117]
    v_pk_mul_f32 v[182:183], v[182:183], v[118:119]
    v_exp_f32 v176, v176
    v_exp_f32 v177, v177
    v_exp_f32 v178, v178
    v_exp_f32 v179, v179
    v_exp_f32 v180, v180
    v_exp_f32 v181, v181
    v_exp_f32 v182, v182
    v_exp_f32 v183, v183
    v_pk_fma_f32 v[108:109], v[148:149], v[164:165], v[108:109] op_sel_hi:[1,0,1]
    v_pk_fma_f32 v[110:111], v[150:151], v[164:165], v[110:111] op_sel_hi:[1,0,1]
    v_pk_fma_f32 v[124:125], v[156:157], v[164:165], v[124:125] op_sel_hi:[1,0,1]
    v_pk_fma_f32 v[126:127], v[158:159], v[164:165], v[126:127] op_sel_hi:[1,0,1]
    v_pk_fma_f32 v[176:177], v[176:177], v[164:165], v[164:165] op_sel:[0,1,1] op_sel_hi:[1,1,1]
    v_pk_fma_f32 v[178:179], v[178:179], v[164:165], v[164:165] op_sel:[0,1,1] op_sel_hi:[1,1,1]
    v_pk_fma_f32 v[180:181], v[180:181], v[164:165], v[164:165] op_sel:[0,1,1] op_sel_hi:[1,1,1]
    v_pk_fma_f32 v[182:183], v[182:183], v[164:165], v[164:165] op_sel:[0,1,1] op_sel_hi:[1,1,1]
    v_rcp_f32 v176, v176
    v_rcp_f32 v177, v177
    v_rcp_f32 v178, v178
    v_rcp_f32 v179, v179
    v_rcp_f32 v180, v180
    v_rcp_f32 v181, v181
    v_rcp_f32 v182, v182
    v_rcp_f32 v183, v183
    v_pk_mul_f32 v[100:101], v[100:101], v[108:109]
    v_pk_mul_f32 v[102:103], v[102:103], v[110:111]
    v_pk_mul_f32 v[116:117], v[116:117], v[124:125]
    v_pk_mul_f32 v[118:119], v[118:119], v[126:127]
    v_pk_mul_f32 v[100:101], v[100:101], v[176:177]
    v_pk_mul_f32 v[102:103], v[102:103], v[178:179]
    v_pk_mul_f32 v[116:117], v[116:117], v[180:181]
    v_pk_mul_f32 v[118:119], v[118:119], v[182:183]
    s_add_u32 s72, s58, 3
    v_mov_b32 v2, s72
    v_mov_b32 v3, s56
    ds_write_b32 v3, v2 offset:40948
    v_cvt_pk_bf16_f32 v188, v100, v101
    v_cvt_pk_bf16_f32 v189, v102, v103
    v_cvt_pk_bf16_f32 v190, v116, v117
    v_cvt_pk_bf16_f32 v191, v118, v119
    buffer_store_dwordx4 v[188:191], v15, s[44:47], s85 offen sc1
    s_add_u32 s92, s92, 4096
    s_add_u32 s93, s93, 4096
    s_add_u32 s94, s94, 4096
    s_add_u32 s95, s95, 4096
    buffer_load_dwordx4 v[160:163], v14, s[44:47], s92 offen offset:0 sc1
    buffer_load_dwordx4 v[164:167], v14, s[44:47], s93 offen offset:0 sc1
    buffer_load_dwordx4 v[168:171], v14, s[44:47], s94 offen offset:0 sc1
    buffer_load_dwordx4 v[172:175], v14, s[44:47], s95 offen offset:0 sc1
    buffer_load_dwordx4 v[176:179], v14, s[44:47], s92 offen offset:1024 sc1
    buffer_load_dwordx4 v[180:183], v14, s[44:47], s93 offen offset:1024 sc1
    v_add_u32 v2, 0, v14
    v_add_u32 v3, 44032, v14
    v_add_u32 v4, 88064, v14
    v_add_u32 v5, 132096, v14
    v_and_b32 v26, 7, v1
    v_lshlrev_b32 v6, 10, v18
    v_lshl_add_u32 v6, v26, 4, v6
    v_mul_u32_u24 v22, 272, v16
    v_lshl_add_u32 v22, v17, 4, v22
    v_add_u32 v22, s56, v22
    s_add_u32 s61, s3, 0
    s_and_b32 s61, s61, 3
    s_lshl_b32 s61, s61, 6
    v_add_u32 v10, s61, v22
    s_add_u32 s61, s3, 1
    s_and_b32 s61, s61, 3
    s_lshl_b32 s61, s61, 6
    v_add_u32 v11, s61, v22
    s_add_u32 s61, s3, 2
    s_and_b32 s61, s61, 3
    s_lshl_b32 s61, s61, 6
    v_add_u32 v12, s61, v22
    s_add_u32 s61, s3, 3
    s_and_b32 s61, s61, 3
    s_lshl_b32 s61, s61, 6
    v_add_u32 v13, s61, v22
    v_mul_u32_u24 v20, 272, v18
    v_lshl_add_u32 v20, v26, 5, v20
    s_mul_i32 s61, s3, 4352
    s_add_u32 s61, s61, 0
    v_add_u32 v20, s61, v20
    v_add_u32 v21, 81920, v20
    v_lshlrev_b32 v7, 13, v17
    v_lshl_add_u32 v7, v16, 4, v7
    v_add_u32 v25, 32768, v7
    v_mul_u32_u24 v8, 144, v17
    v_lshl_add_u32 v8, v19, 2, v8
    v_bfe_u32 v9, v1, 2, 2
    v_lshl_add_u32 v8, v9, 3, v8
    v_add_u32 v8, s56, v8
    v_lshrrev_b32 v9, 2, v1
    v_mul_u32_u24 v9, 144, v9
    v_add3_u32 v9, v9, v19, s56
    s_waitcnt vmcnt(6)
    s_mov_b64 exec, 1
    buffer_store_dwordx2 v[28:29], v30, s[44:47], s37 offen sc1
    s_mov_b64 exec, -1
    buffer_load_dwordx4 v[184:187], v14, s[44:47], s94 offen offset:1024 sc1
    buffer_load_dwordx4 v[188:191], v14, s[44:47], s95 offen offset:1024 sc1
    s_sleep 16
    buffer_load_dwordx2 v[22:23], v24, s[44:47], 0 offen sc1
    s_waitcnt vmcnt(0)
    v_cmp_ne_u64 vcc, s[58:59], v[22:23]
    s_cbranch_vccnz L_plp_2
L_pok_1:
    buffer_load_dwordx4 v[96:99], v2, s[44:47], s73 offen offset:0 sc1
    buffer_load_dwordx4 v[100:103], v3, s[44:47], s73 offen offset:0 sc1
    buffer_load_dwordx4 v[104:107], v4, s[44:47], s73 offen offset:0 sc1
    buffer_load_dwordx4 v[108:111], v5, s[44:47], s73 offen offset:0 sc1
    buffer_load_dwordx4 v[112:115], v2, s[44:47], s73 offen offset:1024 sc1
    buffer_load_dwordx4 v[116:119], v3, s[44:47], s73 offen offset:1024 sc1
    buffer_load_dwordx4 v[120:123], v4, s[44:47], s73 offen offset:1024 sc1
    buffer_load_dwordx4 v[124:127], v5, s[44:47], s73 offen offset:1024 sc1
    buffer_load_dwordx4 v[128:131], v2, s[44:47], s73 offen offset:2048 sc1
    buffer_load_dwordx4 v[132:135], v3, s[44:47], s73 offen offset:2048 sc1
    buffer_load_dwordx4 v[136:139], v4, s[44:47], s73 offen offset:2048 sc1
    buffer_load_dwordx4 v[140:143], v5, s[44:47], s73 offen offset:2048 sc1
    s_waitcnt vmcnt(8)
    v_mfma_f32_16x16x32_bf16 v[32:35], v[192:195], v[96:99], 0
    buffer_load_dwordx4 v[144:147], v2, s[44:47], s73 offen offset:3072 sc1
    v_mfma_f32_16x16x32_bf16 v[48:51], v[196:199], v[96:99], 0
    buffer_load_dwordx4 v[148:151], v3, s[44:47], s73 offen offset:3072 sc1
    v_mfma_f32_16x16x32_bf16 v[64:67], v[200:203], v[96:99], 0
    buffer_load_dwordx4 v[152:155], v4, s[44:47], s73 offen offset:3072 sc1
    v_mfma_f32_16x16x32_bf16 v[80:83], v[204:207], v[96:99], 0
    buffer_load_dwordx4 v[156:159], v5, s[44:47], s73 offen offset:3072 sc1
    v_mfma_f32_16x16x32_bf16 v[36:39], v[192:195], v[100:103], 0
    s_add_u32 s73, s73, 4096
    buffer_load_dwordx4 v[96:99], v2, s[44:47], s73 offen offset:0 sc1
    v_mfma_f32_16x16x32_bf16 v[52:55], v[196:199], v[100:103], 0
    v_mfma_f32_16x16x32_bf16 v[68:71], v[200:203], v[100:103], 0
    v_mfma_f32_16x16x32_bf16 v[84:87], v[204:207], v[100:103], 0
    buffer_load_dwordx4 v[100:103], v3, s[44:47], s73 offen offset:0 sc1
    v_mfma_f32_16x16x32_bf16 v[40:43], v[192:195], v[104:107], 0
    v_mfma_f32_16x16x32_bf16 v[56:59], v[196:199], v[104:107], 0
    v_mfma_f32_16x16x32_bf16 v[72:75], v[200:203], v[104:107], 0
    v_mfma_f32_16x16x32_bf16 v[88:91], v[204:207], v[104:107], 0
    buffer_load_dwordx4 v[104:107], v4, s[44:47], s73 offen offset:0 sc1
    v_mfma_f32_16x16x32_bf16 v[44:47], v[192:195], v[108:111], 0
    buffer_load_dwordx4 v[192:195], v14, s[44:47], s92 offen offset:2048 sc1
    v_mfma_f32_16x16x32_bf16 v[60:63], v[196:199], v[108:111], 0
    buffer_load_dwordx4 v[196:199], v14, s[44:47], s93 offen offset:2048 sc1
    v_mfma_f32_16x16x32_bf16 v[76:79], v[200:203], v[108:111], 0
    buffer_load_dwordx4 v[200:203], v14, s[44:47], s94 offen offset:2048 sc1
    v_mfma_f32_16x16x32_bf16 v[92:95], v[204:207], v[108:111], 0
    buffer_load_dwordx4 v[108:111], v5, s[44:47], s73 offen offset:0 sc1
    s_waitcnt vmcnt(15)
    v_mfma_f32_16x16x32_bf16 v[32:35], v[208:211], v[112:115], v[32:35]
    buffer_load_dwordx4 v[204:207], v14, s[44:47], s95 offen offset:2048 sc1
    v_mfma_f32_16x16x32_bf16 v[48:51], v[212:215], v[112:115], v[48:51]
    v_mfma_f32_16x16x32_bf16 v[64:67], v[216:219], v[112:115], v[64:67]
    v_mfma_f32_16x16x32_bf16 v[80:83], v[220:223], v[112:115], v[80:83]
    buffer_load_dwordx4 v[112:115], v2, s[44:47], s73 offen offset:1024 sc1
    v_mfma_f32_16x16x32_bf16 v[36:39], v[208:211], v[116:119], v[36:39]
    v_mfma_f32_16x16x32_bf16 v[52:55], v[212:215], v[116:119], v[52:55]
    v_mfma_f32_16x16x32_bf16 v[68:71], v[216:219], v[116:119], v[68:71]
    v_mfma_f32_16x16x32_bf16 v[84:87], v[220:223], v[116:119], v[84:87]
    buffer_load_dwordx4 v[116:119], v3, s[44:47], s73 offen offset:1024 sc1
    v_mfma_f32_16x16x32_bf16 v[40:43], v[208:211], v[120:123], v[40:43]
    v_mfma_f32_16x16x32_bf16 v[56:59], v[212:215], v[120:123], v[56:59]
    v_mfma_f32_16x16x32_bf16 v[72:75], v[216:219], v[120:123], v[72:75]
    v_mfma_f32_16x16x32_bf16 v[88:91], v[220:223], v[120:123], v[88:91]
    buffer_load_dwordx4 v[120:123], v4, s[44:47], s73 offen offset:1024 sc1
    v_mfma_f32_16x16x32_bf16 v[44:47], v[208:211], v[124:127], v[44:47]
    v_mfma_f32_16x16x32_bf16 v[60:63], v[212:215], v[124:127], v[60:63]
    v_mfma_f32_16x16x32_bf16 v[76:79], v[216:219], v[124:127], v[76:79]
    v_mfma_f32_16x16x32_bf16 v[92:95], v[220:223], v[124:127], v[92:95]
    buffer_load_dwordx4 v[124:127], v5, s[44:47], s73 offen offset:1024 sc1
    s_waitcnt vmcnt(16)
    v_mfma_f32_16x16x32_bf16 v[32:35], v[224:227], v[128:131], v[32:35]
    v_mfma_f32_16x16x32_bf16 v[48:51], v[228:231], v[128:131], v[48:51]
    v_mfma_f32_16x16x32_bf16 v[64:67], v[232:235], v[128:131], v[64:67]
    v_mfma_f32_16x16x32_bf16 v[80:83], v[236:239], v[128:131], v[80:83]
    buffer_load_dwordx4 v[128:131], v2, s[44:47], s73 offen offset:2048 sc1
    v_mfma_f32_16x16x32_bf16 v[36:39], v[224:227], v[132:135], v[36:39]
    v_mfma_f32_16x16x32_bf16 v[52:55], v[228:231], v[132:135], v[52:55]
    v_mfma_f32_16x16x32_bf16 v[68:71], v[232:235], v[132:135], v[68:71]
    v_mfma_f32_16x16x32_bf16 v[84:87], v[236:239], v[132:135], v[84:87]
    buffer_load_dwordx4 v[132:135], v3, s[44:47], s73 offen offset:2048 sc1
    v_mfma_f32_16x16x32_bf16 v[40:43], v[224:227], v[136:139], v[40:43]
    v_mfma_f32_16x16x32_bf16 v[56:59], v[228:231], v[136:139], v[56:59]
    v_mfma_f32_16x16x32_bf16 v[72:75], v[232:235], v[136:139], v[72:75]
    v_mfma_f32_16x16x32_bf16 v[88:91], v[236:239], v[136:139], v[88:91]
    buffer_load_dwordx4 v[136:139], v4, s[44:47], s73 offen offset:2048 sc1
    v_mfma_f32_16x16x32_bf16 v[44:47], v[224:227], v[140:143], v[44:47]
    v_mfma_f32_16x16x32_bf16 v[60:63], v[228:231], v[140:143], v[60:63]
    v_mfma_f32_16x16x32_bf16 v[76:79], v[232:235], v[140:143], v[76:79]
    v_mfma_f32_16x16x32_bf16 v[92:95], v[236:239], v[140:143], v[92:95]
    buffer_load_dwordx4 v[140:143], v5, s[44:47], s73 offen offset:2048 sc1
    s_waitcnt vmcnt(16)
    v_mfma_f32_16x16x32_bf16 v[32:35], v[240:243], v[144:147], v[32:35]
    v_mfma_f32_16x16x32_bf16 v[48:51], v[244:247], v[144:147], v[48:51]
    v_mfma_f32_16x16x32_bf16 v[64:67], v[248:251], v[144:147], v[64:67]
    v_mfma_f32_16x16x32_bf16 v[80:83], v[252:255], v[144:147], v[80:83]
    v_mfma_f32_16x16x32_bf16 v[36:39], v[240:243], v[148:151], v[36:39]
    v_mfma_f32_16x16x32_bf16 v[52:55], v[244:247], v[148:151], v[52:55]
    v_mfma_f32_16x16x32_bf16 v[68:71], v[248:251], v[148:151], v[68:71]
    v_mfma_f32_16x16x32_bf16 v[84:87], v[252:255], v[148:151], v[84:87]
    v_mfma_f32_16x16x32_bf16 v[40:43], v[240:243], v[152:155], v[40:43]
    v_mfma_f32_16x16x32_bf16 v[56:59], v[244:247], v[152:155], v[56:59]
    v_mfma_f32_16x16x32_bf16 v[72:75], v[248:251], v[152:155], v[72:75]
    v_mfma_f32_16x16x32_bf16 v[88:91], v[252:255], v[152:155], v[88:91]
    v_mfma_f32_16x16x32_bf16 v[44:47], v[240:243], v[156:159], v[44:47]
    v_mfma_f32_16x16x32_bf16 v[60:63], v[244:247], v[156:159], v[60:63]
    v_mfma_f32_16x16x32_bf16 v[76:79], v[248:251], v[156:159], v[76:79]
    v_mfma_f32_16x16x32_bf16 v[92:95], v[252:255], v[156:159], v[92:95]
    s_waitcnt vmcnt(9)
    v_mfma_f32_16x16x32_bf16 v[32:35], v[160:163], v[96:99], v[32:35]
    v_mfma_f32_16x16x32_bf16 v[48:51], v[164:167], v[96:99], v[48:51]
    v_mfma_f32_16x16x32_bf16 v[64:67], v[168:171], v[96:99], v[64:67]
    v_mfma_f32_16x16x32_bf16 v[80:83], v[172:175], v[96:99], v[80:83]
    v_mfma_f32_16x16x32_bf16 v[36:39], v[160:163], v[100:103], v[36:39]
    v_mfma_f32_16x16x32_bf16 v[52:55], v[164:167], v[100:103], v[52:55]
    v_mfma_f32_16x16x32_bf16 v[68:71], v[168:171], v[100:103], v[68:71]
    v_mfma_f32_16x16x32_bf16 v[84:87], v[172:175], v[100:103], v[84:87]
    v_mfma_f32_16x16x32_bf16 v[40:43], v[160:163], v[104:107], v[40:43]
    v_mfma_f32_16x16x32_bf16 v[56:59], v[164:167], v[104:107], v[56:59]
    v_mfma_f32_16x16x32_bf16 v[72:75], v[168:171], v[104:107], v[72:75]
    v_mfma_f32_16x16x32_bf16 v[88:91], v[172:175], v[104:107], v[88:91]
    v_mfma_f32_16x16x32_bf16 v[44:47], v[160:163], v[108:111], v[44:47]
    v_mfma_f32_16x16x32_bf16 v[60:63], v[164:167], v[108:111], v[60:63]
    v_mfma_f32_16x16x32_bf16 v[76:79], v[168:171], v[108:111], v[76:79]
    v_mfma_f32_16x16x32_bf16 v[92:95], v[172:175], v[108:111], v[92:95]
    s_waitcnt vmcnt(4)
    v_mfma_f32_16x16x32_bf16 v[32:35], v[176:179], v[112:115], v[32:35]
    v_mfma_f32_16x16x32_bf16 v[48:51], v[180:183], v[112:115], v[48:51]
    v_mfma_f32_16x16x32_bf16 v[64:67], v[184:187], v[112:115], v[64:67]
    v_mfma_f32_16x16x32_bf16 v[80:83], v[188:191], v[112:115], v[80:83]
    v_mfma_f32_16x16x32_bf16 v[36:39], v[176:179], v[116:119], v[36:39]
    v_mfma_f32_16x16x32_bf16 v[52:55], v[180:183], v[116:119], v[52:55]
    v_mfma_f32_16x16x32_bf16 v[68:71], v[184:187], v[116:119], v[68:71]
    v_mfma_f32_16x16x32_bf16 v[84:87], v[188:191], v[116:119], v[84:87]
    v_mfma_f32_16x16x32_bf16 v[40:43], v[176:179], v[120:123], v[40:43]
    v_mfma_f32_16x16x32_bf16 v[56:59], v[180:183], v[120:123], v[56:59]
    v_mfma_f32_16x16x32_bf16 v[72:75], v[184:187], v[120:123], v[72:75]
    v_mfma_f32_16x16x32_bf16 v[88:91], v[188:191], v[120:123], v[88:91]
    v_mfma_f32_16x16x32_bf16 v[44:47], v[176:179], v[124:127], v[44:47]
    v_mfma_f32_16x16x32_bf16 v[60:63], v[180:183], v[124:127], v[60:63]
    v_mfma_f32_16x16x32_bf16 v[76:79], v[184:187], v[124:127], v[76:79]
    v_mfma_f32_16x16x32_bf16 v[92:95], v[188:191], v[124:127], v[92:95]
    s_waitcnt vmcnt(0)
    v_mfma_f32_16x16x32_bf16 v[32:35], v[192:195], v[128:131], v[32:35]
    v_mfma_f32_16x16x32_bf16 v[48:51], v[196:199], v[128:131], v[48:51]
    v_mfma_f32_16x16x32_bf16 v[64:67], v[200:203], v[128:131], v[64:67]
    v_mfma_f32_16x16x32_bf16 v[80:83], v[204:207], v[128:131], v[80:83]
    v_mfma_f32_16x16x32_bf16 v[36:39], v[192:195], v[132:135], v[36:39]
    v_mfma_f32_16x16x32_bf16 v[52:55], v[196:199], v[132:135], v[52:55]
    v_mfma_f32_16x16x32_bf16 v[68:71], v[200:203], v[132:135], v[68:71]
    v_mfma_f32_16x16x32_bf16 v[84:87], v[204:207], v[132:135], v[84:87]
    v_mfma_f32_16x16x32_bf16 v[40:43], v[192:195], v[136:139], v[40:43]
    v_mfma_f32_16x16x32_bf16 v[56:59], v[196:199], v[136:139], v[56:59]
    v_mfma_f32_16x16x32_bf16 v[72:75], v[200:203], v[136:139], v[72:75]
    v_mfma_f32_16x16x32_bf16 v[88:91], v[204:207], v[136:139], v[88:91]
    v_mfma_f32_16x16x32_bf16 v[44:47], v[192:195], v[140:143], v[44:47]
    v_mfma_f32_16x16x32_bf16 v[60:63], v[196:199], v[140:143], v[60:63]
    v_mfma_f32_16x16x32_bf16 v[76:79], v[200:203], v[140:143], v[76:79]
    v_mfma_f32_16x16x32_bf16 v[92:95], v[204:207], v[140:143], v[92:95]
    buffer_load_dwordx4 v[208:211], v6, s[8:11], s75 offen
    ds_write_b128 v11, v[48:51] offset:0
    ds_write_b128 v11, v[52:55] offset:4352
    ds_write_b128 v11, v[56:59] offset:8704
    s_nop 1
    ds_write_b128 v11, v[60:63] offset:13056
    ds_write_b128 v12, v[64:67] offset:0
    ds_write_b128 v12, v[68:71] offset:4352
    ds_write_b128 v12, v[72:75] offset:8704
    ds_write_b128 v12, v[76:79] offset:13056
    ds_write_b128 v13, v[80:83] offset:0
    ds_write_b128 v13, v[84:87] offset:4352
    ds_write_b128 v13, v[88:91] offset:8704
    ds_write_b128 v13, v[92:95] offset:13056
    s_add_u32 s72, s58, 7
    v_mov_b32 v22, s56
L_hs_3:
    s_sleep 1
    ds_read_b32 v23, v22 offset:40912
    s_add_u32 s101, s101, 1
    s_waitcnt lgkmcnt(0)
    v_readfirstlane_b32 s33, v23
    s_cmp_lt_u32 s101, 4000000
    s_cselect_b32 s33, s33, s72
    s_cmp_lg_u32 s33, s72
    s_cbranch_scc1 L_hs_3
    buffer_load_dwordx4 v[112:115], v7, s[44:47], s77 offen sc1
    buffer_load_dwordx4 v[116:119], v25, s[44:47], s77 offen sc1
    buffer_load_dwordx4 v[120:123], v7, s[44:47], s81 offen sc1
    buffer_load_dwordx4 v[124:127], v25, s[44:47], s81 offen sc1
    s_waitcnt vmcnt(0)
    v_cmp_ne_u64 vcc, s[58:59], v[114:115]
    v_cmp_ne_u64 s[62:63], s[58:59], v[118:119]
    s_nop 0
    s_or_b64 vcc, vcc, s[62:63]
    v_cmp_ne_u64 s[62:63], s[58:59], v[122:123]
    s_nop 0
    s_or_b64 vcc, vcc, s[62:63]
    v_cmp_ne_u64 s[62:63], s[58:59], v[126:127]
    s_nop 0
    s_or_b64 vcc, vcc, s[62:63]
    s_cbranch_vccnz L_alp_5
L_aok_4:
    ds_write_b64 v8, v[112:113] offset:17408
    ds_write_b64 v8, v[116:117] offset:17984
    ds_write_b64 v8, v[120:121] offset:18560
    ds_write_b64 v8, v[124:125] offset:19136
    ds_read_b64_tr_b16 v[224:225], v9 offset:17408
    ds_read_b64_tr_b16 v[226:227], v9 offset:17440
    ds_read_b64_tr_b16 v[228:229], v9 offset:17472
    ds_read_b64_tr_b16 v[230:231], v9 offset:17504
    s_waitcnt lgkmcnt(0)
    v_lshlrev_b32 v232, 16, v224
    v_and_b32 v233, 0xffff0000, v224
    v_lshlrev_b32 v234, 16, v225
    v_and_b32 v235, 0xffff0000, v225
    v_lshlrev_b32 v236, 16, v226
    v_and_b32 v237, 0xffff0000, v226
    v_lshlrev_b32 v238, 16, v227
    v_and_b32 v239, 0xffff0000, v227
    v_lshlrev_b32 v240, 16, v228
    v_and_b32 v241, 0xffff0000, v228
    v_lshlrev_b32 v242, 16, v229
    v_and_b32 v243, 0xffff0000, v229
    v_lshlrev_b32 v244, 16, v230
    v_and_b32 v245, 0xffff0000, v230
    v_lshlrev_b32 v246, 16, v231
    v_and_b32 v247, 0xffff0000, v231
    v_add_f32 v32, v32, v232
    v_add_f32 v33, v33, v233
    v_add_f32 v34, v34, v234
    v_add_f32 v35, v35, v235
    v_add_f32 v36, v36, v236
    v_add_f32 v37, v37, v237
    v_add_f32 v38, v38, v238
    v_add_f32 v39, v39, v239
    v_add_f32 v40, v40, v240
    v_add_f32 v41, v41, v241
    v_add_f32 v42, v42, v242
    v_add_f32 v43, v43, v243
    v_add_f32 v44, v44, v244
    v_add_f32 v45, v45, v245
    v_add_f32 v46, v46, v246
    v_add_f32 v47, v47, v247
    ds_write_b128 v10, v[32:35] offset:0
    ds_write_b128 v10, v[36:39] offset:4352
    ds_write_b128 v10, v[40:43] offset:8704
    ds_write_b128 v10, v[44:47] offset:13056
    v_lshlrev_b32 v96, 16, v208
    v_and_b32 v97, 0xffff0000, v208
    v_lshlrev_b32 v98, 16, v209
    v_and_b32 v99, 0xffff0000, v209
    v_lshlrev_b32 v100, 16, v210
    v_and_b32 v101, 0xffff0000, v210
    v_lshlrev_b32 v102, 16, v211
    v_and_b32 v103, 0xffff0000, v211
    s_waitcnt lgkmcnt(0)
    s_barrier
    ds_read_b128 v[128:131], v20 offset:0
    ds_read_b128 v[132:135], v20 offset:16
    ds_read_b128 v[136:139], v20 offset:40960
    ds_read_b128 v[140:143], v20 offset:40976
    ds_read_b128 v[144:147], v21 offset:0
    ds_read_b128 v[148:151], v21 offset:16
    ds_read_b128 v[152:155], v21 offset:40960
    ds_read_b128 v[156:159], v21 offset:40976
    ds_read_b128 v[160:163], v20 offset:20480
    ds_read_b128 v[164:167], v20 offset:20496
    ds_read_b128 v[168:171], v20 offset:61440
    ds_read_b128 v[172:175], v20 offset:61456
    ds_read_b128 v[176:179], v21 offset:20480
    ds_read_b128 v[180:183], v21 offset:20496
    ds_read_b128 v[184:187], v21 offset:61440
    ds_read_b128 v[188:191], v21 offset:61456
    s_waitcnt lgkmcnt(12)
    v_pk_add_f32 v[128:129], v[128:129], v[136:137]
    v_pk_add_f32 v[130:131], v[130:131], v[138:139]
    v_pk_add_f32 v[132:133], v[132:133], v[140:141]
    v_pk_add_f32 v[134:135], v[134:135], v[142:143]
    v_pk_add_f32 v[96:97], v[96:97], v[128:129]
    v_pk_add_f32 v[98:99], v[98:99], v[130:131]
    v_pk_add_f32 v[100:101], v[100:101], v[132:133]
    v_pk_add_f32 v[102:103], v[102:103], v[134:135]
    s_waitcnt lgkmcnt(8)
    v_pk_add_f32 v[144:145], v[144:145], v[152:153]
    v_pk_add_f32 v[146:147], v[146:147], v[154:155]
    v_pk_add_f32 v[148:149], v[148:149], v[156:157]
    v_pk_add_f32 v[150:151], v[150:151], v[158:159]
    v_pk_add_f32 v[96:97], v[96:97], v[144:145]
    v_pk_add_f32 v[98:99], v[98:99], v[146:147]
    v_pk_add_f32 v[100:101], v[100:101], v[148:149]
    v_pk_add_f32 v[102:103], v[102:103], v[150:151]
    s_waitcnt lgkmcnt(4)
    v_pk_add_f32 v[160:161], v[160:161], v[168:169]
    v_pk_add_f32 v[162:163], v[162:163], v[170:171]
    v_pk_add_f32 v[164:165], v[164:165], v[172:173]
    v_pk_add_f32 v[166:167], v[166:167], v[174:175]
    v_pk_add_f32 v[96:97], v[96:97], v[160:161]
    v_pk_add_f32 v[98:99], v[98:99], v[162:163]
    v_pk_add_f32 v[100:101], v[100:101], v[164:165]
    v_pk_add_f32 v[102:103], v[102:103], v[166:167]
    s_waitcnt lgkmcnt(0)
    v_pk_add_f32 v[176:177], v[176:177], v[184:185]
    v_pk_add_f32 v[178:179], v[178:179], v[186:187]
    v_pk_add_f32 v[180:181], v[180:181], v[188:189]
    v_pk_add_f32 v[182:183], v[182:183], v[190:191]
    v_pk_add_f32 v[96:97], v[96:97], v[176:177]
    v_pk_add_f32 v[98:99], v[98:99], v[178:179]
    v_pk_add_f32 v[100:101], v[100:101], v[180:181]
    v_pk_add_f32 v[102:103], v[102:103], v[182:183]
    v_cvt_pk_bf16_f32 v112, v96, v97
    v_cvt_pk_bf16_f32 v113, v98, v99
    v_cvt_pk_bf16_f32 v114, v100, v101
    v_cvt_pk_bf16_f32 v115, v102, v103
    buffer_store_dwordx4 v[112:115], v6, s[52:55], s75 offen sc1
L_end:
    s_endpgm
L_S:
    v_and_b32 v20, 7, v1
    v_xor_b32 v21, v20, v17
    s_and_b32 s81, s6, 1
    s_lshl_b32 s62, s81, 2
    v_xor_b32 v21, s62, v21
    v_lshlrev_b32 v21, 4, v21
    v_lshl_add_u32 v2, v18, 10, v21
    v_xor_b32 v3, 64, v2
    v_add_u32 v4, 14336, v2
    v_add_u32 v5, 21504, v3
    v_add_u32 v3, 7168, v3
    s_lshl_b32 s64, s87, 15
    s_lshr_b32 s65, s6, 1
    s_mov_b32 s15, 0x20000
    s_cmp_eq_u32 s7, 15
    s_cselect_b32 s14, 0, 1409024
    s_cselect_b32 s64, 1073741824, s64
    s_mul_i32 s66, s86, 44032
    s_add_u32 s66, s66, s68
    s_mul_i32 s62, s81, 88064
    s_sub_u32 s67, s66, s62
    s_add_u32 s67, s67, 88064
    s_add_u32 s66, s66, s62
    s_cmp_eq_u32 s7, 14
    s_cselect_b32 s82, 128, 0
    v_add_u32 v22, 0, v1
    v_mul_u32_u24 v22, 43691, v22
    v_lshrrev_b32 v22, 19, v22
    v_mul_u32_u24 v23, 192, v22
    v_sub_u32 v23, v14, v23
    v_add_u32 v23, 0, v23
    v_cmp_gt_u32 vcc, s82, v23
    v_and_b32 v23, 8, v22
    v_lshlrev_b32 v23, 2, v23
    v_xor_b32 v23, v23, v14
    v_mul_u32_u24 v22, 2560, v22
    v_add_u32 v22, v22, v23
    v_cndmask_b32 v6, v22, 2.0, vcc
    v_add_u32 v22, 64, v1
    v_mul_u32_u24 v22, 43691, v22
    v_lshrrev_b32 v22, 19, v22
    v_mul_u32_u24 v23, 192, v22
    v_sub_u32 v23, v14, v23
    v_add_u32 v23, 1024, v23
    v_cmp_gt_u32 vcc, s82, v23
    v_and_b32 v23, 8, v22
    v_lshlrev_b32 v23, 2, v23
    v_xor_b32 v23, v23, v14
    v_mul_u32_u24 v22, 2560, v22
    v_add_u32 v22, v22, v23
    v_cndmask_b32 v7, v22, 2.0, vcc
    v_add_u32 v22, 128, v1
    v_mul_u32_u24 v22, 43691, v22
    v_lshrrev_b32 v22, 19, v22
    v_mul_u32_u24 v23, 192, v22
    v_sub_u32 v23, v14, v23
    v_add_u32 v23, 2048, v23
    v_cmp_gt_u32 vcc, s82, v23
    v_and_b32 v23, 8, v22
    v_lshlrev_b32 v23, 2, v23
    v_xor_b32 v23, v23, v14
    v_mul_u32_u24 v22, 2560, v22
    v_add_u32 v22, v22, v23
    v_cndmask_b32 v8, v22, 2.0, vcc
    s_lshl_b32 s72, s69, 7
    v_lshl_add_u32 v24, v1, 1, s72
    s_and_b32 s72, s69, -2
    v_mov_b32 v25, s72
    s_xor_b32 s61, s65, 0
    s_add_u32 m0, s56, 0
    s_lshl_b32 s62, s61, 7
    s_add_u32 s62, s62, s64
    s_mul_i32 s63, s61, 176128
    s_waitcnt lgkmcnt(0)
    s_mov_b32 s8, s16
    s_mov_b32 s9, s17
    global_load_ushort v250, v24, s[18:19]
    global_load_ushort v251, v24, s[20:21]
    global_load_ushort v252, v24, s[22:23]
    global_load_ushort v253, v24, s[24:25]
    global_load_ushort v254, v25, s[26:27]
    global_load_ushort v249, v25, s[28:29]
    buffer_load_dwordx4 v2, s[8:11], s62 offen offset:0 lds
    buffer_load_dwordx4 v3, s[8:11], s62 offen offset:1024 lds
    buffer_load_dwordx4 v4, s[8:11], s62 offen offset:2048 lds
    buffer_load_dwordx4 v5, s[8:11], s62 offen offset:3072 lds
    s_load_dwordx2 s[58:59], s[42:43], 0
    s_bitcmp1_b32 s3, 0
    s_cselect_b32 s12, s34, s32
    s_cselect_b32 s13, s35, s33
    s_add_u32 m0, s56, 4096
    s_add_u32 s62, s63, s66
    buffer_load_dwordx4 v6, s[12:15], s62 offen offset:0 lds
    buffer_load_dwordx4 v7, s[12:15], s62 offen offset:1024 lds
    buffer_load_dwordx4 v8, s[12:15], s62 offen offset:2048 lds
    s_add_u32 m0, s56, 7168
    s_add_u32 s62, s63, s67
    buffer_load_dwordx4 v6, s[12:15], s62 offen offset:0 lds
    buffer_load_dwordx4 v7, s[12:15], s62 offen offset:1024 lds
    buffer_load_dwordx4 v8, s[12:15], s62 offen offset:2048 lds
    s_mov_b32 s44, s42
    s_mov_b32 s45, s43
    s_mov_b32 s46, 33554432
    s_mov_b32 s47, 0x20000
    s_mov_b32 s30, s38
    s_mov_b32 s31, s39
    v_and_b32 v16, 15, v1
    s_mul_i32 s89, s86, 81920
    s_xor_b32 s72, s3, 1
    s_mul_i32 s60, s72, 40960
    v_add_u32 v15, 44032, v14
    s_add_u32 s35, s56, 0
    v_and_b32 v20, 31, v1
    v_lshrrev_b32 v21, 5, v1
    v_bfe_u32 v19, v1, 1, 2
    v_lshlrev_b32 v19, 4, v19
    v_lshl_add_u32 v184, v1, 6, v19
    v_add_u32 v184, s35, v184
    v_xor_b32 v185, 16, v184
    v_xor_b32 v186, 32, v184
    v_xor_b32 v187, 48, v184
    v_and_b32 v19, 1, v17
    v_bfe_u32 v22, v1, 1, 1
    v_lshl_add_u32 v19, v19, 1, v22
    v_bfe_u32 v22, v1, 3, 1
    v_xor_b32 v19, v19, v22
    v_lshlrev_b32 v19, 4, v19
    v_bfe_u32 v22, v1, 2, 2
    v_lshl_add_u32 v22, v22, 6, v19
    v_and_b32 v19, 1, v1
    v_lshl_add_u32 v22, v19, 3, v22
    v_lshl_add_u32 v22, v21, 12, v22
    v_add_u32 v22, s35, v22
    v_xor_b32 v23, 32, v22
    s_min_u32 s39, s69, 1
    s_lshl_b32 s39, s39, 30
    s_lshl_b32 s38, s2, 8
    s_lshl_b32 s72, s71, 7
    s_add_u32 s38, s38, s72
    s_lshl_b32 s72, s86, 3
    s_add_u32 s38, s38, s72
    s_add_u32 s38, s38, 131072
    s_lshl_b32 s40, s57, 5
    s_add_u32 s40, s40, 1048576
    s_add_u32 s41, s40, 1048576
    s_mul_i32 s76, s7, 12288
    s_mul_i32 s72, s3, 192
    s_add_u32 s76, s76, s72
    s_add_u32 s76, s76, 262144
    s_lshl_b32 s77, s87, 8
    s_add_u32 s77, s77, 196608
    s_lshl_b32 s87, s69, 12
    s_add_u32 s87, s87, 16777216
    s_lshl_b32 s34, s71, 6
    s_add_u32 s34, s34, s56
    s_add_u32 s34, s34, 35072
    s_sub_u32 s48, 0, s71
    s_mov_b32 s49, s48
    s_mov_b32 s54, 0xaaaaaaaa
    s_mov_b32 s55, 0xaaaaaaaa
    s_or_b64 s[50:51], s[48:49], s[54:55]
    s_and_b64 s[52:53], s[48:49], s[54:55]
    s_and_b64 s[54:55], s[48:49], 1
    s_and_b32 s79, s5, 3
    s_lshl_b32 s72, s4, 2
    s_add_u32 s79, s79, s72
    s_lshr_b32 s80, s5, 2
    s_lshl_b32 s74, s80, 2
    s_add_u32 s74, s74, s3
    s_mul_i32 s78, s80, 172
    s_mul_i32 s72, s3, 11
    s_add_u32 s78, s78, s72
    s_lshl_b32 s78, s78, 10
    s_add_u32 s78, s78, 12582912
    s_and_b32 s88, s71, s86
    s_lshl_b32 s88, s88, 30
    s_add_u32 s72, s3, 0
    s_and_b32 s72, s72, 3
    s_mul_i32 s72, s72, 44032
    s_add_u32 s92, s72, s78
    s_add_u32 s72, s3, 1
    s_and_b32 s72, s72, 3
    s_mul_i32 s72, s72, 44032
    s_add_u32 s93, s72, s78
    s_add_u32 s72, s3, 2
    s_and_b32 s72, s72, 3
    s_mul_i32 s72, s72, 44032
    s_add_u32 s94, s72, s78
    s_add_u32 s72, s3, 3
    s_and_b32 s72, s72, 3
    s_mul_i32 s72, s72, 44032
    s_add_u32 s95, s72, s78
    v_and_b32 v19, 255, v0
    v_lshlrev_b32 v9, 5, v19
    v_add_u32 v9, 4096, v9
    v_lshrrev_b32 v26, 1, v19
    v_and_b32 v19, 1, v19
    v_lshlrev_b32 v10, 13, v26
    v_lshl_add_u32 v10, v19, 4, v10
    v_mul_u32_u24 v11, 81920, v19
    v_lshl_add_u32 v11, v26, 4, v11
    v_min_u32 v19, 11, v16
    v_lshlrev_b32 v19, 4, v19
    v_mul_u32_u24 v12, 3072, v17
    v_add_u32 v12, v12, v19
    s_mul_i32 s72, s3, 192
    s_add_u32 s72, s72, 61440
    v_add_u32 v191, s72, v19
    v_lshlrev_b32 v26, 3, v20
    v_add_u32 v27, s56, v14
    v_lshl_add_u32 v182, v20, 4, s56
    v_add_u32 v60, s60, v14
    v_lshl_add_u32 v61, v21, 5, v20
    v_sub_u32 v61, 191, v61
    v_lshl_add_u32 v61, v61, 4, s34
    v_lshl_add_u32 v62, v21, 6, v20
    v_sub_u32 v62, 95, v62
    v_lshl_add_u32 v62, v62, 4, s34
    v_add_u32 v63, s34, v14
    v_min_u32 v183, 464, v14
    v_add_u32 v183, s89, v183
    v_mov_b32 v124, 0
    v_mov_b32 v125, 0
    v_mov_b32 v126, 0
    v_mov_b32 v127, 0
    v_mov_b32 v120, 0
    v_mov_b32 v121, 0
    v_mov_b32 v122, 0
    v_mov_b32 v123, 0
    s_xor_b32 s72, s71, 1
    s_lshl_b32 s72, s72, 8
    s_add_u32 s72, s72, s89
    v_lshlrev_b32 v176, 5, v16
    v_lshl_add_u32 v176, v17, 4, v176
    v_add_u32 v176, s72, v176
    v_and_b32 v20, 1, v16
    v_xor_b32 v20, 1, v20
    v_sub_u32 v177, v20, v16
    v_add_u32 v177, 15, v177
    v_lshlrev_b32 v177, 1, v177
    v_lshl_add_u32 v177, v17, 4, v177
    v_mul_u32_u24 v20, 41024, v20
    v_add3_u32 v177, v177, v20, s72
    v_add_u32 v177, 35072, v177
    v_add_u32 v178, 1024, v177
    v_add_u32 v179, 2048, v177
    v_add_u32 v180, 3072, v177
    s_waitcnt lgkmcnt(0)
    s_mul_i32 s58, s58, 0x9e3779b5
    s_add_u32 s58, s58, 0x7f4a7c15
    s_mul_i32 s59, s59, 0x85ebca6d
    s_add_u32 s59, s59, 0x2545f491
    v_mov_b32 v28, s58
    v_mov_b32 v29, s59
    v_mov_b32 v30, 0
    s_lshl_b32 s72, s79, 2
    s_add_u32 s72, s72, s3
    s_lshl_b32 s72, s72, 14
    s_add_u32 s96, s30, s72
    s_addc_u32 s97, s31, 0
    s_load_dword s16, s[96:97], 0
    s_load_dword s17, s[96:97], 4096
    s_load_dword s18, s[96:97], 8192
    s_load_dword s19, s[96:97], 12288
    s_mov_b32 s72, 4194304
    s_load_dword s20, s[42:43], s72
    s_mov_b32 s72, 6291456
    s_load_dword s21, s[42:43], s72
    s_mov_b32 s72, 8388608
    s_load_dword s22, s[42:43], s72
    s_mov_b32 s72, 16777216
    s_load_dword s23, s[42:43], s72
    s_mov_b32 s72, 18874368
    s_load_dword s24, s[42:43], s72
    s_xor_b32 s61, s65, 1
    s_add_u32 m0, s56, 10240
    s_lshl_b32 s62, s61, 7
    s_add_u32 s62, s62, s64
    s_mul_i32 s63, s61, 176128
    s_waitcnt vmcnt(10)
    v_lshlrev_b32 v250, 16, v250
    v_lshlrev_b32 v251, 16, v251
    v_lshlrev_b32 v252, 16, v252
    buffer_load_dwordx4 v2, s[8:11], s62 offen offset:0 lds
    v_lshlrev_b32 v253, 16, v253
    v_lshlrev_b32 v254, 16, v254
    v_lshlrev_b32 v13, 16, v249
    buffer_load_dwordx4 v3, s[8:11], s62 offen offset:1024 lds
    v_mul_f32 v250, 0x3fb8aa3b, v250
    v_mul_f32 v254, 0x3fb8aa3b, v254
    v_exp_f32 v250, v250
    buffer_load_dwordx4 v4, s[8:11], s62 offen offset:2048 lds
    v_exp_f32 v254, v254
    s_nop 0
    v_cvt_pk_bf16_f32 v250, v250, v254
    v_and_b32 v254, 0xffff0000, v250
    v_lshlrev_b32 v250, 16, v250
    buffer_load_dwordx4 v5, s[8:11], s62 offen offset:3072 lds
    v_mul_f32 v250, v250, v254
    v_mul_f32 v251, v251, v254
    v_mul_f32 v250, 0xbfb8aa3b, v250
    s_add_u32 m0, s56, 14336
    s_add_u32 s62, s63, s66
    v_mul_f32 v251, 0x3e22f983, v251
    v_add_f32 v254, v254, v254
    v_mul_f32 v252, v252, v254
    buffer_load_dwordx4 v6, s[12:15], s62 offen offset:0 lds
    v_mul_f32 v253, v253, v254
    v_mul_f32 v216, 0x41000000, v250
    v_mul_f32 v218, 0x3f800000, v250
    v_mul_f32 v220, 0x43800000, v250
    buffer_load_dwordx4 v7, s[12:15], s62 offen offset:1024 lds
    v_mul_f32 v217, 0x41000000, v251
    v_mul_f32 v219, 0x3f800000, v251
    v_mul_f32 v221, 0x43800000, v251
    buffer_load_dwordx4 v8, s[12:15], s62 offen offset:2048 lds
    v_exp_f32 v216, v216
    v_exp_f32 v218, v218
    v_exp_f32 v220, v220
    s_waitcnt vmcnt(7)
    s_barrier
    s_add_u32 m0, s56, 17408
    s_add_u32 s62, s63, s67
    buffer_load_dwordx4 v6, s[12:15], s62 offen offset:0 lds
    buffer_load_dwordx4 v7, s[12:15], s62 offen offset:1024 lds
    buffer_load_dwordx4 v8, s[12:15], s62 offen offset:2048 lds
    s_xor_b32 s61, s65, 2
    s_add_u32 m0, s56, 20480
    s_lshl_b32 s62, s61, 7
    s_add_u32 s62, s62, s64
    s_mul_i32 s63, s61, 176128
    v_fract_f32 v217, v217
    v_fract_f32 v219, v219
    buffer_load_dwordx4 v2, s[8:11], s62 offen offset:0 lds
    v_fract_f32 v221, v221
    v_cos_f32 v230, v217
    buffer_load_dwordx4 v3, s[8:11], s62 offen offset:1024 lds
    v_cos_f32 v224, v219
    buffer_load_dwordx4 v4, s[8:11], s62 offen offset:2048 lds
    v_cos_f32 v234, v221
    v_sin_f32 v231, v217
    buffer_load_dwordx4 v5, s[8:11], s62 offen offset:3072 lds
    v_sin_f32 v225, v219
    s_add_u32 m0, s56, 24576
    s_add_u32 s62, s63, s66
    v_sin_f32 v235, v221
    v_mul_f32 v230, v230, v216
    buffer_load_dwordx4 v6, s[12:15], s62 offen offset:0 lds
    v_mul_f32 v224, v224, v218
    buffer_load_dwordx4 v7, s[12:15], s62 offen offset:1024 lds
    v_mul_f32 v234, v234, v220
    v_mul_f32 v231, v231, v216
    buffer_load_dwordx4 v8, s[12:15], s62 offen offset:2048 lds
    v_mul_f32 v225, v225, v218
    s_add_u32 m0, s56, 27648
    s_add_u32 s62, s63, s67
    v_mul_f32 v235, v235, v220
    v_mul_f32 v232, v230, v230
    buffer_load_dwordx4 v6, s[12:15], s62 offen offset:0 lds
    v_mul_f32 v226, v224, v224
    buffer_load_dwordx4 v7, s[12:15], s62 offen offset:1024 lds
    v_mul_f32 v233, v230, v231
    v_mul_f32 v227, v224, v225
    buffer_load_dwordx4 v8, s[12:15], s62 offen offset:2048 lds
    v_fma_f32 v232, -v231, v231, v232
    s_waitcnt vmcnt(10)
    s_barrier
    s_xor_b32 s61, s65, 3
    s_add_u32 m0, s56, 0
    s_lshl_b32 s62, s61, 7
    s_add_u32 s62, s62, s64
    s_mul_i32 s63, s61, 176128
    v_fma_f32 v226, -v225, v225, v226
    v_fmac_f32 v233, v231, v230
    v_fmac_f32 v227, v225, v224
    v_mul_f32 v228, v226, v226
    v_mul_f32 v229, v226, v227
    buffer_load_dwordx4 v2, s[8:11], s62 offen offset:0 lds
    v_fma_f32 v228, -v227, v227, v228
    v_fmac_f32 v229, v227, v226
    v_cvt_pk_bf16_f32 v128, 1.0, v230
    v_cvt_pk_bf16_f32 v144, 0, v231
    buffer_load_dwordx4 v3, s[8:11], s62 offen offset:1024 lds
    v_mul_f32 v222, v230, v232
    v_mul_f32 v223, v230, v233
    v_fma_f32 v222, -v231, v233, v222
    v_fmac_f32 v223, v231, v232
    buffer_load_dwordx4 v4, s[8:11], s62 offen offset:2048 lds
    v_cvt_pk_bf16_f32 v129, v232, v222
    v_cvt_pk_bf16_f32 v145, v233, v223
    v_mul_f32 v216, v232, v232
    v_mul_f32 v220, v222, v232
    buffer_load_dwordx4 v5, s[8:11], s62 offen offset:3072 lds
    v_mul_f32 v217, v232, v233
    v_mul_f32 v221, v222, v233
    v_fma_f32 v216, -v233, v233, v216
    v_fma_f32 v220, -v223, v233, v220
    v_fmac_f32 v217, v233, v232
    s_add_u32 m0, s56, 4096
    s_add_u32 s62, s63, s66
    v_fmac_f32 v221, v223, v232
    v_cvt_pk_bf16_f32 v130, v216, v220
    v_cvt_pk_bf16_f32 v146, v217, v221
    v_mul_f32 v218, v216, v232
    buffer_load_dwordx4 v6, s[12:15], s62 offen offset:0 lds
    v_mul_f32 v222, v220, v232
    v_mul_f32 v219, v216, v233
    v_mul_f32 v223, v220, v233
    v_fma_f32 v218, -v217, v233, v218
    buffer_load_dwordx4 v7, s[12:15], s62 offen offset:1024 lds
    v_fma_f32 v222, -v221, v233, v222
    v_fmac_f32 v219, v217, v232
    v_fmac_f32 v223, v221, v232
    v_cvt_pk_bf16_f32 v131, v218, v222
    buffer_load_dwordx4 v8, s[12:15], s62 offen offset:2048 lds
    v_cvt_pk_bf16_f32 v147, v219, v223
    v_mul_f32 v216, v218, v232
    v_mul_f32 v220, v222, v232
    v_mul_f32 v217, v218, v233
    v_mul_f32 v221, v222, v233
    s_add_u32 m0, s56, 7168
    s_add_u32 s62, s63, s67
    v_fma_f32 v216, -v219, v233, v216
    v_fma_f32 v220, -v223, v233, v220
    v_fmac_f32 v217, v219, v232
    v_fmac_f32 v221, v223, v232
    buffer_load_dwordx4 v6, s[12:15], s62 offen offset:0 lds
    v_cvt_pk_bf16_f32 v132, v216, v220
    v_cvt_pk_bf16_f32 v148, v217, v221
    v_mul_f32 v218, v216, v232
    v_mul_f32 v222, v220, v232
    buffer_load_dwordx4 v7, s[12:15], s62 offen offset:1024 lds
    v_mul_f32 v219, v216, v233
    v_mul_f32 v223, v220, v233
    v_fma_f32 v218, -v217, v233, v218
    v_fma_f32 v222, -v221, v233, v222
    buffer_load_dwordx4 v8, s[12:15], s62 offen offset:2048 lds
    v_fmac_f32 v219, v217, v232
    v_fmac_f32 v223, v221, v232
    v_cvt_pk_bf16_f32 v133, v218, v222
    v_cvt_pk_bf16_f32 v149, v219, v223
    s_waitcnt vmcnt(10)
    s_barrier
    s_xor_b32 s61, s65, 4
    s_add_u32 m0, s56, 10240
    s_lshl_b32 s62, s61, 7
    s_add_u32 s62, s62, s64
    s_mul_i32 s63, s61, 176128
    v_mul_f32 v216, v218, v232
    v_mul_f32 v220, v222, v232
    v_mul_f32 v217, v218, v233
    v_mul_f32 v221, v222, v233
    v_fma_f32 v216, -v219, v233, v216
    buffer_load_dwordx4 v2, s[8:11], s62 offen offset:0 lds
    v_fma_f32 v220, -v223, v233, v220
    v_fmac_f32 v217, v219, v232
    v_fmac_f32 v221, v223, v232
    v_cvt_pk_bf16_f32 v134, v216, v220
    v_cvt_pk_bf16_f32 v150, v217, v221
    buffer_load_dwordx4 v3, s[8:11], s62 offen offset:1024 lds
    v_mul_f32 v218, v216, v232
    v_mul_f32 v222, v220, v232
    v_mul_f32 v219, v216, v233
    v_mul_f32 v223, v220, v233
    buffer_load_dwordx4 v4, s[8:11], s62 offen offset:2048 lds
    v_fma_f32 v218, -v217, v233, v218
    v_fma_f32 v222, -v221, v233, v222
    v_fmac_f32 v219, v217, v232
    v_fmac_f32 v223, v221, v232
    v_cvt_pk_bf16_f32 v135, v218, v222
    buffer_load_dwordx4 v5, s[8:11], s62 offen offset:3072 lds
    v_cvt_pk_bf16_f32 v151, v219, v223
    v_mul_f32 v216, v218, v232
    v_mul_f32 v220, v222, v232
    v_mul_f32 v217, v218, v233
    v_mul_f32 v221, v222, v233
    s_add_u32 m0, s56, 14336
    s_add_u32 s62, s63, s66
    v_fma_f32 v216, -v219, v233, v216
    v_fma_f32 v220, -v223, v233, v220
    v_fmac_f32 v217, v219, v232
    v_fmac_f32 v221, v223, v232
    buffer_load_dwordx4 v6, s[12:15], s62 offen offset:0 lds
    v_cvt_pk_bf16_f32 v136, v216, v220
    v_cvt_pk_bf16_f32 v152, v217, v221
    v_mul_f32 v218, v216, v232
    v_mul_f32 v222, v220, v232
    v_mul_f32 v219, v216, v233
    buffer_load_dwordx4 v7, s[12:15], s62 offen offset:1024 lds
    v_mul_f32 v223, v220, v233
    v_fma_f32 v218, -v217, v233, v218
    v_fma_f32 v222, -v221, v233, v222
    v_fmac_f32 v219, v217, v232
    buffer_load_dwordx4 v8, s[12:15], s62 offen offset:2048 lds
    v_fmac_f32 v223, v221, v232
    v_cvt_pk_bf16_f32 v137, v218, v222
    v_cvt_pk_bf16_f32 v153, v219, v223
    v_mul_f32 v216, v218, v232
    v_mul_f32 v220, v222, v232
    s_add_u32 m0, s56, 17408
    s_add_u32 s62, s63, s67
    v_mul_f32 v217, v218, v233
    v_mul_f32 v221, v222, v233
    v_fma_f32 v216, -v219, v233, v216
    v_fma_f32 v220, -v223, v233, v220
    v_fmac_f32 v217, v219, v232
    buffer_load_dwordx4 v6, s[12:15], s62 offen offset:0 lds
    v_fmac_f32 v221, v223, v232
    v_cvt_pk_bf16_f32 v138, v216, v220
    v_cvt_pk_bf16_f32 v154, v217, v221
    v_mul_f32 v218, v216, v232
    buffer_load_dwordx4 v7, s[12:15], s62 offen offset:1024 lds
    v_mul_f32 v222, v220, v232
    v_mul_f32 v219, v216, v233
    v_mul_f32 v223, v220, v233
    v_fma_f32 v218, -v217, v233, v218
    v_fma_f32 v222, -v221, v233, v222
    buffer_load_dwordx4 v8, s[12:15], s62 offen offset:2048 lds
    v_fmac_f32 v219, v217, v232
    v_fmac_f32 v223, v221, v232
    v_cvt_pk_bf16_f32 v139, v218, v222
    v_cvt_pk_bf16_f32 v155, v219, v223
    s_waitcnt vmcnt(10)
    s_barrier
    s_xor_b32 s61, s65, 5
    s_add_u32 m0, s56, 20480
    s_lshl_b32 s62, s61, 7
    s_add_u32 s62, s62, s64
    s_mul_i32 s63, s61, 176128
    v_mul_f32 v216, v218, v232
    v_mul_f32 v220, v222, v232
    v_mul_f32 v217, v218, v233
    v_mul_f32 v221, v222, v233
    v_fma_f32 v216, -v219, v233, v216
    buffer_load_dwordx4 v2, s[8:11], s62 offen offset:0 lds
    v_fma_f32 v220, -v223, v233, v220
    v_fmac_f32 v217, v219, v232
    v_fmac_f32 v221, v223, v232
    v_cvt_pk_bf16_f32 v140, v216, v220
    v_cvt_pk_bf16_f32 v156, v217, v221
    buffer_load_dwordx4 v3, s[8:11], s62 offen offset:1024 lds
    v_mul_f32 v218, v216, v232
    v_mul_f32 v222, v220, v232
    v_mul_f32 v219, v216, v233
    v_mul_f32 v223, v220, v233
    buffer_load_dwordx4 v4, s[8:11], s62 offen offset:2048 lds
    v_fma_f32 v218, -v217, v233, v218
    v_fma_f32 v222, -v221, v233, v222
    v_fmac_f32 v219, v217, v232
    v_fmac_f32 v223, v221, v232
    v_cvt_pk_bf16_f32 v141, v218, v222
    buffer_load_dwordx4 v5, s[8:11], s62 offen offset:3072 lds
    v_cvt_pk_bf16_f32 v157, v219, v223
    v_mul_f32 v216, v218, v232
    v_mul_f32 v220, v222, v232
    v_mul_f32 v217, v218, v233
    v_mul_f32 v221, v222, v233
    s_add_u32 m0, s56, 24576
    s_add_u32 s62, s63, s66
    v_fma_f32 v216, -v219, v233, v216
    v_fma_f32 v220, -v223, v233, v220
    v_fmac_f32 v217, v219, v232
    v_fmac_f32 v221, v223, v232
    buffer_load_dwordx4 v6, s[12:15], s62 offen offset:0 lds
    v_cvt_pk_bf16_f32 v142, v216, v220
    v_cvt_pk_bf16_f32 v158, v217, v221
    v_mul_f32 v218, v216, v232
    v_mul_f32 v222, v220, v232
    v_mul_f32 v219, v216, v233
    buffer_load_dwordx4 v7, s[12:15], s62 offen offset:1024 lds
    v_mul_f32 v223, v220, v233
    v_fma_f32 v218, -v217, v233, v218
    v_fma_f32 v222, -v221, v233, v222
    v_fmac_f32 v219, v217, v232
    buffer_load_dwordx4 v8, s[12:15], s62 offen offset:2048 lds
    v_fmac_f32 v223, v221, v232
    v_cvt_pk_bf16_f32 v143, v218, v222
    v_cvt_pk_bf16_f32 v159, v219, v223
    v_mul_f32 v64, v252, v224
    v_mul_f32 v236, v252, v234
    s_add_u32 m0, s56, 27648
    s_add_u32 s62, s63, s67
    v_mul_f32 v65, v252, v225
    v_mul_f32 v237, v252, v235
    v_fma_f32 v64, -v253, v225, v64
    v_fma_f32 v236, -v253, v235, v236
    v_fmac_f32 v65, v253, v224
    buffer_load_dwordx4 v6, s[12:15], s62 offen offset:0 lds
    v_fmac_f32 v237, v253, v234
    v_mul_f32 v66, v64, v224
    v_mul_f32 v238, v236, v234
    v_mul_f32 v67, v64, v225
    buffer_load_dwordx4 v7, s[12:15], s62 offen offset:1024 lds
    v_mul_f32 v239, v236, v235
    v_fma_f32 v66, -v65, v225, v66
    v_fma_f32 v238, -v237, v235, v238
    v_fmac_f32 v67, v65, v224
    v_fmac_f32 v239, v237, v234
    buffer_load_dwordx4 v8, s[12:15], s62 offen offset:2048 lds
    v_mul_f32 v68, v66, v224
    v_mul_f32 v240, v238, v234
    v_mul_f32 v69, v66, v225
    v_mul_f32 v241, v238, v235
    s_waitcnt vmcnt(10)
    s_barrier
    s_xor_b32 s61, s65, 6
    s_add_u32 m0, s56, 0
    s_lshl_b32 s62, s61, 7
    s_add_u32 s62, s62, s64
    s_mul_i32 s63, s61, 176128
    v_fma_f32 v68, -v67, v225, v68
    v_fma_f32 v240, -v239, v235, v240
    v_fmac_f32 v69, v67, v224
    v_fmac_f32 v241, v239, v234
    v_mul_f32 v70, v68, v224
    buffer_load_dwordx4 v2, s[8:11], s62 offen offset:0 lds
    v_mul_f32 v242, v240, v234
    v_mul_f32 v71, v68, v225
    v_mul_f32 v243, v240, v235
    v_fma_f32 v70, -v69, v225, v70
    v_fma_f32 v242, -v241, v235, v242
    buffer_load_dwordx4 v3, s[8:11], s62 offen offset:1024 lds
    v_fmac_f32 v71, v69, v224
    v_fmac_f32 v243, v241, v234
    v_mul_f32 v72, v70, v224
    v_mul_f32 v244, v242, v234
    buffer_load_dwordx4 v4, s[8:11], s62 offen offset:2048 lds
    v_mul_f32 v73, v70, v225
    v_mul_f32 v245, v242, v235
    v_fma_f32 v72, -v71, v225, v72
    v_fma_f32 v244, -v243, v235, v244
    v_fmac_f32 v73, v71, v224
    buffer_load_dwordx4 v5, s[8:11], s62 offen offset:3072 lds
    v_fmac_f32 v245, v243, v234
    v_mul_f32 v74, v72, v224
    v_mul_f32 v246, v244, v234
    v_mul_f32 v75, v72, v225
    v_mul_f32 v247, v244, v235
    s_add_u32 m0, s56, 4096
    s_add_u32 s62, s63, s66
    v_fma_f32 v74, -v73, v225, v74
    v_fma_f32 v246, -v245, v235, v246
    v_fmac_f32 v75, v73, v224
    v_fmac_f32 v247, v245, v234
    buffer_load_dwordx4 v6, s[12:15], s62 offen offset:0 lds
    v_mul_f32 v76, v74, v224
    v_mul_f32 v248, v246, v234
    v_mul_f32 v77, v74, v225
    v_mul_f32 v249, v246, v235
    v_fma_f32 v76, -v75, v225, v76
    buffer_load_dwordx4 v7, s[12:15], s62 offen offset:1024 lds
    v_fma_f32 v248, -v247, v235, v248
    v_fmac_f32 v77, v75, v224
    v_fmac_f32 v249, v247, v234
    v_mul_f32 v78, v76, v224
    buffer_load_dwordx4 v8, s[12:15], s62 offen offset:2048 lds
    v_mul_f32 v92, v236, v226
    v_mul_f32 v79, v76, v225
    v_mul_f32 v93, v236, v227
    v_fma_f32 v78, -v77, v225, v78
    v_fma_f32 v92, -v237, v227, v92
    s_add_u32 m0, s56, 7168
    s_add_u32 s62, s63, s67
    v_fmac_f32 v79, v77, v224
    v_fmac_f32 v93, v237, v226
    v_mul_f32 v80, v242, v230
    v_mul_f32 v94, v92, v226
    v_mul_f32 v81, v242, v231
    buffer_load_dwordx4 v6, s[12:15], s62 offen offset:0 lds
    v_mul_f32 v95, v92, v227
    v_fma_f32 v80, -v243, v231, v80
    v_fma_f32 v94, -v93, v227, v94
    v_fmac_f32 v81, v243, v230
    buffer_load_dwordx4 v7, s[12:15], s62 offen offset:1024 lds
    v_fmac_f32 v95, v93, v226
    v_mul_f32 v82, v244, v230
    v_mul_f32 v96, v94, v226
    v_mul_f32 v83, v244, v231
    v_mul_f32 v97, v94, v227
    buffer_load_dwordx4 v8, s[12:15], s62 offen offset:2048 lds
    v_fma_f32 v82, -v245, v231, v82
    v_fma_f32 v96, -v95, v227, v96
    v_fmac_f32 v83, v245, v230
    v_fmac_f32 v97, v95, v226
    s_waitcnt vmcnt(10)
    s_barrier
    s_xor_b32 s61, s65, 7
    s_add_u32 m0, s56, 10240
    s_lshl_b32 s62, s61, 7
    s_add_u32 s62, s62, s64
    s_mul_i32 s63, s61, 176128
    v_mul_f32 v84, v246, v230
    v_mul_f32 v98, v96, v226
    v_mul_f32 v85, v246, v231
    v_mul_f32 v99, v96, v227
    buffer_load_dwordx4 v2, s[8:11], s62 offen offset:0 lds
    v_fma_f32 v84, -v247, v231, v84
    v_fma_f32 v98, -v97, v227, v98
    v_fmac_f32 v85, v247, v230
    v_fmac_f32 v99, v97, v226
    buffer_load_dwordx4 v3, s[8:11], s62 offen offset:1024 lds
    v_mul_f32 v86, v248, v230
    v_mul_f32 v100, v238, v228
    v_mul_f32 v87, v248, v231
    v_mul_f32 v101, v238, v229
    buffer_load_dwordx4 v4, s[8:11], s62 offen offset:2048 lds
    v_fma_f32 v86, -v249, v231, v86
    v_fma_f32 v100, -v239, v229, v100
    v_fmac_f32 v87, v249, v230
    v_fmac_f32 v101, v239, v228
    buffer_load_dwordx4 v5, s[8:11], s62 offen offset:3072 lds
    v_mul_f32 v88, v240, v228
    v_mul_f32 v102, v100, v228
    v_mul_f32 v89, v240, v229
    v_mul_f32 v103, v100, v229
    buffer_load_dwordx2 v[188:189], v9, s[44:47], 0 offen sc1
    v_fma_f32 v88, -v241, v229, v88
    v_fma_f32 v102, -v101, v229, v102
    v_fmac_f32 v89, v241, v228
    v_fmac_f32 v103, v101, v228
    s_add_u32 m0, s56, 14336
    s_add_u32 s62, s63, s66
    v_mul_f32 v90, v88, v228
    v_mul_f32 v91, v88, v229
    v_fma_f32 v90, -v89, v229, v90
    v_fmac_f32 v91, v89, v228
    buffer_load_dwordx4 v6, s[12:15], s62 offen offset:0 lds
    v_cvt_pk_bf16_f32 v160, v252, v64
    v_cvt_pk_bf16_f32 v104, -v253, -v65
    v_cvt_pk_bf16_f32 v161, v66, v68
    v_cvt_pk_bf16_f32 v105, -v67, -v69
    buffer_load_dwordx4 v7, s[12:15], s62 offen offset:1024 lds
    v_cvt_pk_bf16_f32 v162, v236, v236
    v_cvt_pk_bf16_f32 v106, -v237, -v237
    v_cvt_pk_bf16_f32 v163, v92, v94
    v_cvt_pk_bf16_f32 v107, -v93, -v95
    buffer_load_dwordx4 v8, s[12:15], s62 offen offset:2048 lds
    v_cvt_pk_bf16_f32 v164, v70, v72
    v_cvt_pk_bf16_f32 v108, -v71, -v73
    v_cvt_pk_bf16_f32 v165, v74, v76
    v_cvt_pk_bf16_f32 v109, -v75, -v77
    s_add_u32 m0, s56, 17408
    s_add_u32 s62, s63, s67
    v_cvt_pk_bf16_f32 v166, v94, v94
    v_cvt_pk_bf16_f32 v110, -v95, -v95
    v_cvt_pk_bf16_f32 v167, v96, v98
    v_cvt_pk_bf16_f32 v111, -v97, -v99
    buffer_load_dwordx4 v6, s[12:15], s62 offen offset:0 lds
    v_cvt_pk_bf16_f32 v168, v78, v238
    v_cvt_pk_bf16_f32 v112, -v79, -v239
    v_cvt_pk_bf16_f32 v169, v100, v102
    v_cvt_pk_bf16_f32 v113, -v101, -v103
    buffer_load_dwordx4 v7, s[12:15], s62 offen offset:1024 lds
    v_cvt_pk_bf16_f32 v170, v98, v240
    v_cvt_pk_bf16_f32 v114, -v99, -v241
    v_cvt_pk_bf16_f32 v171, v88, v90
    v_cvt_pk_bf16_f32 v115, -v89, -v91
    buffer_load_dwordx4 v8, s[12:15], s62 offen offset:2048 lds
    v_cvt_pk_bf16_f32 v172, v242, v80
    v_cvt_pk_bf16_f32 v116, -v243, -v81
    v_cvt_pk_bf16_f32 v173, v244, v82
    s_waitcnt vmcnt(6)
    v_cmp_ne_u64 vcc, s[58:59], v[188:189]
    s_cbranch_vccnz L_plp_7
L_pok_6:
    s_barrier
    buffer_load_dwordx4 v[32:35], v12, s[44:47], s76 offen offset:0 sc1
    buffer_load_dwordx4 v[36:39], v12, s[44:47], s76 offen offset:768 sc1
    buffer_load_dwordx4 v[40:43], v12, s[44:47], s76 offen offset:1536 sc1
    buffer_load_dwordx4 v[44:47], v12, s[44:47], s76 offen offset:2304 sc1
    buffer_load_dwordx2 v[48:49], v26, s[44:47], s77 offen sc1
    buffer_load_dwordx4 v[52:55], v10, s[44:47], s40 offen sc1
    buffer_load_dwordx4 v[56:59], v10, s[44:47], s41 offen sc1
    v_cvt_pk_bf16_f32 v117, -v245, -v83
    v_cvt_pk_bf16_f32 v174, v246, v84
    v_cvt_pk_bf16_f32 v118, -v247, -v85
    v_cvt_pk_bf16_f32 v175, v248, v86
    v_cvt_pk_bf16_f32 v119, -v249, -v87
    s_waitcnt vmcnt(7)
    s_barrier
    s_sub_u32 s72, s58, 1
    v_mov_b32 v188, s72
    v_min_u32 v189, 11, v1
    v_lshl_add_u32 v189, v189, 2, s56
    ds_write_b32 v189, v188 offset:40912
    s_waitcnt vmcnt(2)
    v_add_f32 v32, v32, v36
    v_add_f32 v33, v33, v37
    v_add_f32 v34, v34, v38
    v_add_f32 v35, v35, v39
    v_add_f32 v40, v40, v44
    v_add_f32 v41, v41, v45
    v_add_f32 v42, v42, v46
    v_add_f32 v43, v43, v47
    v_add_f32 v32, v32, v40
    v_add_f32 v33, v33, v41
    v_add_f32 v34, v34, v42
    v_add_f32 v35, v35, v43
    v_mov_b32 v36, v32
    v_mov_b32 v37, v33
    v_mov_b32 v38, v34
    v_mov_b32 v39, v35
    v_permlane32_swap_b32 v32, v36
    v_permlane32_swap_b32 v33, v37
    v_permlane32_swap_b32 v34, v38
    v_permlane32_swap_b32 v35, v39
    v_add_f32 v32, v32, v36
    v_add_f32 v33, v33, v37
    v_add_f32 v34, v34, v38
    v_add_f32 v35, v35, v39
    v_mov_b32 v36, v32
    v_mov_b32 v37, v33
    v_mov_b32 v38, v34
    v_mov_b32 v39, v35
    v_permlane16_swap_b32 v32, v36
    v_permlane16_swap_b32 v33, v37
    v_permlane16_swap_b32 v34, v38
    v_permlane16_swap_b32 v35, v39
    v_add_f32 v32, v32, v36
    v_add_f32 v33, v33, v37
    v_add_f32 v34, v34, v38
    v_add_f32 v35, v35, v39
    v_rcp_f32 v50, v49
    v_mul_f32 v49, v49, v49
    v_mul_f32 v51, v50, v50
    v_mul_f32 v50, 0xc0135761, v50
    v_mul_f32 v51, v51, v50
    v_mul_f32 v51, 0x3d372713, v51
    ds_write_b128 v191, v[32:35]
    ds_write_b128 v182, v[48:51] offset:40192
    s_waitcnt vmcnt(0)
    ds_write_b128 v11, v[52:55] offset:20960
    ds_write_b128 v11, v[56:59] offset:23008
    ds_write_b128 v183, v[120:123] offset:20480
    s_waitcnt lgkmcnt(0)
    s_barrier
    s_add_u32 s72, s92, 7168
    buffer_load_dwordx4 v[192:195], v14, s[44:47], s72 offen sc1
    s_add_u32 s72, s93, 7168
    buffer_load_dwordx4 v[196:199], v14, s[44:47], s72 offen sc1
    s_add_u32 s72, s94, 7168
    buffer_load_dwordx4 v[200:203], v14, s[44:47], s72 offen sc1
    s_add_u32 s72, s95, 7168
    buffer_load_dwordx4 v[204:207], v14, s[44:47], s72 offen sc1
    s_add_u32 s72, s92, 8192
    buffer_load_dwordx4 v[208:211], v14, s[44:47], s72 offen sc1
    s_add_u32 s72, s93, 8192
    buffer_load_dwordx4 v[212:215], v14, s[44:47], s72 offen sc1
    s_add_u32 s72, s94, 8192
    buffer_load_dwordx4 v[216:219], v14, s[44:47], s72 offen sc1
    s_add_u32 s72, s95, 8192
    buffer_load_dwordx4 v[220:223], v14, s[44:47], s72 offen sc1
    ds_write_b128 v184, v[128:131] offset:30720
    ds_write_b128 v185, v[132:135] offset:30720
    ds_write_b128 v186, v[136:139] offset:30720
    ds_write_b128 v187, v[140:143] offset:30720
    ds_write_b128 v184, v[144:147] offset:34816
    ds_write_b128 v185, v[148:151] offset:34816
    ds_write_b128 v186, v[152:155] offset:34816
    ds_write_b128 v187, v[156:159] offset:34816
    ds_read_b64_tr_b16 v[64:65], v22 offset:30720
    ds_read_b64_tr_b16 v[66:67], v23 offset:30976
    ds_read_b64_tr_b16 v[68:69], v22 offset:31232
    ds_read_b64_tr_b16 v[70:71], v23 offset:31488
    ds_read_b64_tr_b16 v[72:73], v22 offset:31744
    ds_read_b64_tr_b16 v[74:75], v23 offset:32000
    ds_read_b64_tr_b16 v[76:77], v22 offset:32256
    ds_read_b64_tr_b16 v[78:79], v23 offset:32512
    ds_read_b64_tr_b16 v[80:81], v22 offset:32768
    ds_read_b64_tr_b16 v[82:83], v23 offset:33024
    ds_read_b64_tr_b16 v[84:85], v22 offset:33280
    ds_read_b64_tr_b16 v[86:87], v23 offset:33536
    ds_read_b64_tr_b16 v[88:89], v22 offset:33792
    ds_read_b64_tr_b16 v[90:91], v23 offset:34048
    ds_read_b64_tr_b16 v[92:93], v22 offset:34304
    ds_read_b64_tr_b16 v[94:95], v23 offset:34560
    ds_write_b128 v184, v[160:163] offset:30720
    ds_write_b128 v185, v[164:167] offset:30720
    ds_write_b128 v186, v[168:171] offset:30720
    ds_write_b128 v187, v[172:175] offset:30720
    ds_write_b128 v184, v[104:107] offset:34816
    ds_write_b128 v185, v[108:111] offset:34816
    ds_write_b128 v186, v[112:115] offset:34816
    ds_write_b128 v187, v[116:119] offset:34816
    ds_read_b64_tr_b16 v[128:129], v22 offset:30720
    ds_read_b64_tr_b16 v[130:131], v23 offset:30976
    ds_read_b64_tr_b16 v[132:133], v22 offset:31232
    ds_read_b64_tr_b16 v[134:135], v23 offset:31488
    ds_read_b64_tr_b16 v[136:137], v22 offset:31744
    ds_read_b64_tr_b16 v[138:139], v23 offset:32000
    ds_read_b64_tr_b16 v[140:141], v22 offset:32256
    ds_read_b64_tr_b16 v[142:143], v23 offset:32512
    ds_read_b64_tr_b16 v[144:145], v22 offset:32768
    ds_read_b64_tr_b16 v[146:147], v23 offset:33024
    ds_read_b64_tr_b16 v[148:149], v22 offset:33280
    ds_read_b64_tr_b16 v[150:151], v23 offset:33536
    ds_read_b64_tr_b16 v[152:153], v22 offset:33792
    ds_read_b64_tr_b16 v[154:155], v23 offset:34048
    ds_read_b64_tr_b16 v[156:157], v22 offset:34304
    ds_read_b64_tr_b16 v[158:159], v23 offset:34560
    s_add_u32 s72, s92, 9216
    buffer_load_dwordx4 v[224:227], v14, s[44:47], s72 offen sc1
    s_add_u32 s72, s93, 9216
    buffer_load_dwordx4 v[228:231], v14, s[44:47], s72 offen sc1
    s_add_u32 s72, s94, 9216
    buffer_load_dwordx4 v[232:235], v14, s[44:47], s72 offen sc1
    s_add_u32 s72, s95, 9216
    buffer_load_dwordx4 v[236:239], v14, s[44:47], s72 offen sc1
    s_add_u32 s92, s92, s88
    s_add_u32 s72, s92, 10240
    buffer_load_dwordx4 v[240:243], v14, s[44:47], s72 offen sc1
    s_add_u32 s93, s93, s88
    s_add_u32 s72, s93, 10240
    buffer_load_dwordx4 v[244:247], v14, s[44:47], s72 offen sc1
    s_add_u32 s94, s94, s88
    s_add_u32 s72, s94, 10240
    buffer_load_dwordx4 v[248:251], v14, s[44:47], s72 offen sc1
    s_add_u32 s95, s95, s88
    s_add_u32 s72, s95, 10240
    buffer_load_dwordx4 v[252:255], v14, s[44:47], s72 offen sc1
    s_waitcnt lgkmcnt(0)
    s_setprio 2
    v_mfma_f32_32x32x16_bf16 v[160:175], v[128:131], v[64:67], 0
    v_mfma_f32_32x32x16_bf16 v[160:175], v[132:135], v[68:71], v[160:175]
    v_mfma_f32_32x32x16_bf16 v[160:175], v[136:139], v[72:75], v[160:175]
    v_mfma_f32_32x32x16_bf16 v[160:175], v[140:143], v[76:79], v[160:175]
    v_mfma_f32_32x32x16_bf16 v[160:175], v[144:147], v[80:83], v[160:175]
    v_mfma_f32_32x32x16_bf16 v[160:175], v[148:151], v[84:87], v[160:175]
    v_mfma_f32_32x32x16_bf16 v[160:175], v[152:155], v[88:91], v[160:175]
    v_mfma_f32_32x32x16_bf16 v[160:175], v[156:159], v[92:95], v[160:175]
    s_setprio 0
    s_mov_b64 exec, 1
    buffer_store_dwordx2 v[28:29], v30, s[44:47], s39 offen sc1
    s_mov_b64 exec, -1
    s_setprio 2
    s_nop 6
    ds_write_b128 v27, v[160:163] offset:30720
    ds_write_b128 v27, v[164:167] offset:31744
    ds_write_b128 v27, v[168:171] offset:32768
    ds_write_b128 v27, v[172:175] offset:33792
    s_add_u32 s72, s58, 1
    v_mov_b32 v188, s72
    v_mov_b32 v189, s56
    ds_write_b32 v189, v188 offset:40952
    s_add_u32 s72, s58, 1
    v_mov_b32 v190, s60
L_hs_8:
    ds_read_b32 v191, v190 offset:40952
    s_add_u32 s101, s101, 1
    s_waitcnt lgkmcnt(0)
    v_readfirstlane_b32 s33, v191
    s_cmp_lt_u32 s101, 4000000
    s_cselect_b32 s33, s33, s72
    s_cmp_lg_u32 s33, s72
    s_cbranch_scc1 L_hs_8
    ds_read_b128 v[64:67], v60 offset:30720
    ds_read_b128 v[68:71], v60 offset:31744
    ds_read_b128 v[72:75], v60 offset:32768
    ds_read_b128 v[76:79], v60 offset:33792
    s_waitcnt lgkmcnt(0)
    v_pk_add_f32 v[160:161], v[160:161], v[64:65]
    v_pk_add_f32 v[162:163], v[162:163], v[66:67]
    v_pk_add_f32 v[164:165], v[164:165], v[68:69]
    v_pk_add_f32 v[166:167], v[166:167], v[70:71]
    v_pk_add_f32 v[168:169], v[168:169], v[72:73]
    v_pk_add_f32 v[170:171], v[170:171], v[74:75]
    v_pk_add_f32 v[172:173], v[172:173], v[76:77]
    v_pk_add_f32 v[174:175], v[174:175], v[78:79]
    v_cvt_pk_bf16_f32 v124, v160, 0
    v_cndmask_b32 v124, 0, v124, s[54:55]
    v_cndmask_b32 v64, v160, v161, s[48:49]
    v_cndmask_b32 v65, v161, v162, s[48:49]
    v_cndmask_b32 v66, v162, v163, s[48:49]
    v_cndmask_b32 v67, v163, v164, s[48:49]
    v_cndmask_b32 v68, v164, v165, s[48:49]
    v_cndmask_b32 v69, v165, v166, s[48:49]
    v_cndmask_b32 v70, v166, v167, s[48:49]
    v_cndmask_b32 v71, v167, v168, s[48:49]
    v_cvt_pk_bf16_f32 v80, v71, v70
    v_cvt_pk_bf16_f32 v81, v69, v68
    v_cvt_pk_bf16_f32 v82, v67, v66
    v_cvt_pk_bf16_f32 v83, v65, v64
    v_cndmask_b32 v72, v170, v171, s[48:49]
    v_cndmask_b32 v73, v169, v170, s[48:49]
    v_cvt_pk_bf16_f32 v84, v171, v171
    v_cvt_pk_bf16_f32 v85, v72, v170
    v_cvt_pk_bf16_f32 v86, v170, v73
    v_cvt_pk_bf16_f32 v87, v169, v169
    v_cndmask_b32 v74, v172, v173, s[50:51]
    v_cndmask_b32 v75, v172, v173, s[52:53]
    v_cvt_pk_bf16_f32 v88, v173, v173
    v_cvt_pk_bf16_f32 v89, v173, v74
    v_cvt_pk_bf16_f32 v90, v75, v172
    v_cvt_pk_bf16_f32 v91, v172, v172
    v_cndmask_b32 v74, v174, v175, s[50:51]
    v_cndmask_b32 v75, v174, v175, s[52:53]
    v_cvt_pk_bf16_f32 v92, v175, v175
    v_cvt_pk_bf16_f32 v93, v175, v74
    v_cvt_pk_bf16_f32 v94, v75, v174
    v_cvt_pk_bf16_f32 v95, v174, v174
    ds_write_b128 v61, v[80:83] offset:1024
    ds_write_b128 v61, v[84:87]
    ds_write_b128 v62, v[88:91] offset:512
    ds_write_b128 v62, v[92:95]
    s_mov_b64 exec, 3
    ds_write_b128 v63, v[124:127] offset:4096
    s_mov_b64 exec, -1
    s_add_u32 s72, s58, 5
    v_mov_b32 v188, s72
    v_mov_b32 v189, s56
    ds_write_b32 v189, v188 offset:40928
    s_add_u32 s72, s58, 5
    v_mov_b32 v190, s60
L_hs_9:
    ds_read_b32 v191, v190 offset:40928
    s_add_u32 s101, s101, 1
    s_waitcnt lgkmcnt(0)
    v_readfirstlane_b32 s33, v191
    s_cmp_lt_u32 s101, 4000000
    s_cselect_b32 s33, s33, s72
    s_cmp_lg_u32 s33, s72
    s_cbranch_scc1 L_hs_9
    s_setprio 0
    ds_read2_b32 v[92:93], v177 offset0:48 offset1:49
    ds_read2_b32 v[94:95], v177 offset0:50 offset1:51
    ds_read_b128 v[96:99], v176 offset:20672
    ds_read2_b32 v[88:89], v177 offset0:176 offset1:177
    ds_read2_b32 v[90:91], v177 offset0:178 offset1:179
    ds_read_b128 v[100:103], v176 offset:21184
    ds_read2_b32 v[84:85], v178 offset0:48 offset1:49
    ds_read2_b32 v[86:87], v178 offset0:50 offset1:51
    ds_read_b128 v[104:107], v176 offset:21696
    ds_read2_b32 v[80:81], v178 offset0:176 offset1:177
    ds_read2_b32 v[82:83], v178 offset0:178 offset1:179
    ds_read_b128 v[108:111], v176 offset:22208
    ds_read2_b32 v[76:77], v179 offset0:48 offset1:49
    ds_read2_b32 v[78:79], v179 offset0:50 offset1:51
    ds_read_b128 v[112:115], v176 offset:22720
    ds_read2_b32 v[72:73], v179 offset0:176 offset1:177
    ds_read2_b32 v[74:75], v179 offset0:178 offset1:179
    ds_read_b128 v[116:119], v176 offset:23232
    ds_read2_b32 v[68:69], v180 offset0:48 offset1:49
    ds_read2_b32 v[70:71], v180 offset0:50 offset1:51
    ds_read_b128 v[120:123], v176 offset:23744
    ds_read2_b32 v[64:65], v180 offset0:176 offset1:177
    ds_read2_b32 v[66:67], v180 offset0:178 offset1:179
    ds_read_b128 v[124:127], v176 offset:24256
    s_mov_b32 s52, s30
    s_mov_b32 s53, s31
    s_mov_b32 s54, 2097152
    s_mov_b32 s55, 0x20000
    s_add_u32 s72, s58, 3
    v_mov_b32 v172, s56
L_hs_10:
    s_sleep 1
    ds_read_b32 v173, v172 offset:40948
    s_add_u32 s101, s101, 1
    s_waitcnt lgkmcnt(0)
    v_readfirstlane_b32 s33, v173
    s_cmp_lt_u32 s101, 4000000
    s_cselect_b32 s33, s33, s72
    s_cmp_lg_u32 s33, s72
    s_cbranch_scc1 L_hs_10
    s_setprio 2
    v_mfma_f32_16x16x32_bf16 v[60:63], v[92:95], v[96:99], 0
    ds_read2_b32 v[92:93], v177 offset0:32 offset1:33
    ds_read2_b32 v[94:95], v177 offset0:34 offset1:35
    v_mfma_f32_16x16x32_bf16 v[56:59], v[88:91], v[96:99], 0
    v_mfma_f32_16x16x32_bf16 v[60:63], v[88:91], v[100:103], v[60:63]
    ds_read2_b32 v[88:89], v177 offset0:160 offset1:161
    ds_read2_b32 v[90:91], v177 offset0:162 offset1:163
    v_mfma_f32_16x16x32_bf16 v[52:55], v[84:87], v[96:99], 0
    v_mfma_f32_16x16x32_bf16 v[56:59], v[84:87], v[100:103], v[56:59]
    v_lshlrev_b32 v8, 5, v16
    v_mfma_f32_16x16x32_bf16 v[60:63], v[84:87], v[104:107], v[60:63]
    ds_read2_b32 v[84:85], v178 offset0:32 offset1:33
    ds_read2_b32 v[86:87], v178 offset0:34 offset1:35
    v_mfma_f32_16x16x32_bf16 v[48:51], v[80:83], v[96:99], 0
    v_lshl_add_u32 v8, v17, 3, v8
    v_mfma_f32_16x16x32_bf16 v[52:55], v[80:83], v[100:103], v[52:55]
    s_lshl_b32 s72, s71, 11
    v_mfma_f32_16x16x32_bf16 v[56:59], v[80:83], v[104:107], v[56:59]
    s_add_u32 s72, s72, s89
    v_mfma_f32_16x16x32_bf16 v[60:63], v[80:83], v[108:111], v[60:63]
    ds_read2_b32 v[80:81], v178 offset0:160 offset1:161
    ds_read2_b32 v[82:83], v178 offset0:162 offset1:163
    v_mfma_f32_16x16x32_bf16 v[44:47], v[76:79], v[96:99], 0
    v_add_u32 v7, s72, v8
    v_mfma_f32_16x16x32_bf16 v[48:51], v[76:79], v[100:103], v[48:51]
    v_lshrrev_b32 v8, 2, v16
    v_mfma_f32_16x16x32_bf16 v[52:55], v[76:79], v[104:107], v[52:55]
    v_lshlrev_b32 v8, 8, v8
    v_mfma_f32_16x16x32_bf16 v[56:59], v[76:79], v[108:111], v[56:59]
    v_lshl_add_u32 v8, v17, 6, v8
    v_mfma_f32_16x16x32_bf16 v[60:63], v[76:79], v[112:115], v[60:63]
    ds_read2_b32 v[76:77], v179 offset0:32 offset1:33
    ds_read2_b32 v[78:79], v179 offset0:34 offset1:35
    v_mfma_f32_16x16x32_bf16 v[40:43], v[72:75], v[96:99], 0
    v_and_b32 v9, 3, v1
    v_mfma_f32_16x16x32_bf16 v[44:47], v[72:75], v[100:103], v[44:47]
    v_lshl_add_u32 v8, v9, 4, v8
    v_mfma_f32_16x16x32_bf16 v[48:51], v[72:75], v[104:107], v[48:51]
    v_add_u32 v9, s60, v14
    v_mfma_f32_16x16x32_bf16 v[52:55], v[72:75], v[108:111], v[52:55]
    v_mov_b32 v181, v13
    v_mfma_f32_16x16x32_bf16 v[56:59], v[72:75], v[112:115], v[56:59]
    v_mov_b32 v150, v28
    v_mfma_f32_16x16x32_bf16 v[60:63], v[72:75], v[116:119], v[60:63]
    ds_read2_b32 v[72:73], v179 offset0:160 offset1:161
    ds_read2_b32 v[74:75], v179 offset0:162 offset1:163
    v_mfma_f32_16x16x32_bf16 v[36:39], v[68:71], v[96:99], 0
    v_mov_b32 v151, v29
    v_mfma_f32_16x16x32_bf16 v[40:43], v[68:71], v[100:103], v[40:43]
    v_mov_b32 v154, v28
    v_mfma_f32_16x16x32_bf16 v[44:47], v[68:71], v[104:107], v[44:47]
    v_mov_b32 v155, v29
    v_mfma_f32_16x16x32_bf16 v[48:51], v[68:71], v[108:111], v[48:51]
    v_mov_b32 v158, v28
    v_mfma_f32_16x16x32_bf16 v[52:55], v[68:71], v[112:115], v[52:55]
    v_mov_b32 v159, v29
    v_mfma_f32_16x16x32_bf16 v[56:59], v[68:71], v[116:119], v[56:59]
    v_mov_b32 v162, v28
    v_mfma_f32_16x16x32_bf16 v[60:63], v[68:71], v[120:123], v[60:63]
    ds_read2_b32 v[68:69], v180 offset0:32 offset1:33
    ds_read2_b32 v[70:71], v180 offset0:34 offset1:35
    v_mfma_f32_16x16x32_bf16 v[32:35], v[64:67], v[96:99], 0
    ds_read_b128 v[96:99], v176 offset:20608
    v_mfma_f32_16x16x32_bf16 v[36:39], v[64:67], v[100:103], v[36:39]
    ds_read_b128 v[100:103], v176 offset:21120
    v_mfma_f32_16x16x32_bf16 v[40:43], v[64:67], v[104:107], v[40:43]
    ds_read_b128 v[104:107], v176 offset:21632
    v_mfma_f32_16x16x32_bf16 v[44:47], v[64:67], v[108:111], v[44:47]
    ds_read_b128 v[108:111], v176 offset:22144
    v_mfma_f32_16x16x32_bf16 v[48:51], v[64:67], v[112:115], v[48:51]
    ds_read_b128 v[112:115], v176 offset:22656
    v_mfma_f32_16x16x32_bf16 v[52:55], v[64:67], v[116:119], v[52:55]
    ds_read_b128 v[116:119], v176 offset:23168
    v_mfma_f32_16x16x32_bf16 v[56:59], v[64:67], v[120:123], v[56:59]
    ds_read_b128 v[120:123], v176 offset:23680
    v_mfma_f32_16x16x32_bf16 v[60:63], v[64:67], v[124:127], v[60:63]
    ds_read_b128 v[124:127], v176 offset:24192
    ds_read2_b32 v[64:65], v180 offset0:160 offset1:161
    ds_read2_b32 v[66:67], v180 offset0:162 offset1:163
    s_waitcnt lgkmcnt(9)
    v_mfma_f32_16x16x32_bf16 v[60:63], v[92:95], v[96:99], v[60:63]
    ds_read2_b32 v[92:93], v177 offset0:16 offset1:17
    ds_read2_b32 v[94:95], v177 offset0:18 offset1:19
    v_mfma_f32_16x16x32_bf16 v[56:59], v[88:91], v[96:99], v[56:59]
    v_mov_b32 v163, v29
    s_waitcnt lgkmcnt(10)
    v_mfma_f32_16x16x32_bf16 v[60:63], v[88:91], v[100:103], v[60:63]
    ds_read2_b32 v[88:89], v177 offset0:144 offset1:145
    ds_read2_b32 v[90:91], v177 offset0:146 offset1:147
    v_mfma_f32_16x16x32_bf16 v[52:55], v[84:87], v[96:99], v[52:55]
    v_add_u32 v2, 0, v14
    v_mfma_f32_16x16x32_bf16 v[56:59], v[84:87], v[100:103], v[56:59]
    v_add_u32 v3, 44032, v14
    s_waitcnt lgkmcnt(11)
    v_mfma_f32_16x16x32_bf16 v[60:63], v[84:87], v[104:107], v[60:63]
    ds_read2_b32 v[84:85], v178 offset0:16 offset1:17
    ds_read2_b32 v[86:87], v178 offset0:18 offset1:19
    v_mfma_f32_16x16x32_bf16 v[48:51], v[80:83], v[96:99], v[48:51]
    v_add_u32 v4, 88064, v14
    v_mfma_f32_16x16x32_bf16 v[52:55], v[80:83], v[100:103], v[52:55]
    v_add_u32 v5, 132096, v14
    v_mfma_f32_16x16x32_bf16 v[56:59], v[80:83], v[104:107], v[56:59]
    v_and_b32 v26, 7, v1
    s_waitcnt lgkmcnt(12)
    v_mfma_f32_16x16x32_bf16 v[60:63], v[80:83], v[108:111], v[60:63]
    ds_read2_b32 v[80:81], v178 offset0:144 offset1:145
    ds_read2_b32 v[82:83], v178 offset0:146 offset1:147
    v_mfma_f32_16x16x32_bf16 v[44:47], v[76:79], v[96:99], v[44:47]
    v_lshlrev_b32 v6, 10, v18
    v_mfma_f32_16x16x32_bf16 v[48:51], v[76:79], v[100:103], v[48:51]
    v_lshl_add_u32 v6, v26, 4, v6
    v_mfma_f32_16x16x32_bf16 v[52:55], v[76:79], v[104:107], v[52:55]
    v_mul_u32_u24 v22, 272, v16
    v_mfma_f32_16x16x32_bf16 v[56:59], v[76:79], v[108:111], v[56:59]
    v_lshl_add_u32 v22, v17, 4, v22
    s_waitcnt lgkmcnt(13)
    v_mfma_f32_16x16x32_bf16 v[60:63], v[76:79], v[112:115], v[60:63]
    ds_read2_b32 v[76:77], v179 offset0:16 offset1:17
    ds_read2_b32 v[78:79], v179 offset0:18 offset1:19
    v_mfma_f32_16x16x32_bf16 v[40:43], v[72:75], v[96:99], v[40:43]
    v_add_u32 v22, s56, v22
    v_mfma_f32_16x16x32_bf16 v[44:47], v[72:75], v[100:103], v[44:47]
    s_add_u32 s61, s3, 0
    v_mfma_f32_16x16x32_bf16 v[48:51], v[72:75], v[104:107], v[48:51]
    s_and_b32 s61, s61, 3
    v_mfma_f32_16x16x32_bf16 v[52:55], v[72:75], v[108:111], v[52:55]
    s_lshl_b32 s61, s61, 6
    v_mfma_f32_16x16x32_bf16 v[56:59], v[72:75], v[112:115], v[56:59]
    v_add_u32 v10, s61, v22
    s_waitcnt lgkmcnt(14)
    v_mfma_f32_16x16x32_bf16 v[60:63], v[72:75], v[116:119], v[60:63]
    ds_read2_b32 v[72:73], v179 offset0:144 offset1:145
    ds_read2_b32 v[74:75], v179 offset0:146 offset1:147
    v_mfma_f32_16x16x32_bf16 v[36:39], v[68:71], v[96:99], v[36:39]
    s_add_u32 s61, s3, 1
    v_mfma_f32_16x16x32_bf16 v[40:43], v[68:71], v[100:103], v[40:43]
    s_and_b32 s61, s61, 3
    v_mfma_f32_16x16x32_bf16 v[44:47], v[68:71], v[104:107], v[44:47]
    s_lshl_b32 s61, s61, 6
    v_mfma_f32_16x16x32_bf16 v[48:51], v[68:71], v[108:111], v[48:51]
    v_add_u32 v11, s61, v22
    v_mfma_f32_16x16x32_bf16 v[52:55], v[68:71], v[112:115], v[52:55]
    s_add_u32 s61, s3, 2
    v_mfma_f32_16x16x32_bf16 v[56:59], v[68:71], v[116:119], v[56:59]
    s_and_b32 s61, s61, 3
    s_waitcnt lgkmcnt(15)
    v_mfma_f32_16x16x32_bf16 v[60:63], v[68:71], v[120:123], v[60:63]
    ds_read2_b32 v[68:69], v180 offset0:16 offset1:17
    ds_read2_b32 v[70:71], v180 offset0:18 offset1:19
    s_waitcnt lgkmcnt(14)
    v_mfma_f32_16x16x32_bf16 v[32:35], v[64:67], v[96:99], v[32:35]
    ds_read_b128 v[96:99], v176 offset:20544
    v_mfma_f32_16x16x32_bf16 v[36:39], v[64:67], v[100:103], v[36:39]
    ds_read_b128 v[100:103], v176 offset:21056
    v_mfma_f32_16x16x32_bf16 v[40:43], v[64:67], v[104:107], v[40:43]
    ds_read_b128 v[104:107], v176 offset:21568
    v_mfma_f32_16x16x32_bf16 v[44:47], v[64:67], v[108:111], v[44:47]
    ds_read_b128 v[108:111], v176 offset:22080
    v_mfma_f32_16x16x32_bf16 v[48:51], v[64:67], v[112:115], v[48:51]
    ds_read_b128 v[112:115], v176 offset:22592
    v_mfma_f32_16x16x32_bf16 v[52:55], v[64:67], v[116:119], v[52:55]
    ds_read_b128 v[116:119], v176 offset:23104
    v_mfma_f32_16x16x32_bf16 v[56:59], v[64:67], v[120:123], v[56:59]
    ds_read_b128 v[120:123], v176 offset:23616
    v_mfma_f32_16x16x32_bf16 v[60:63], v[64:67], v[124:127], v[60:63]
    ds_read_b128 v[124:127], v176 offset:24128
    ds_read2_b32 v[64:65], v180 offset0:144 offset1:145
    ds_read2_b32 v[66:67], v180 offset0:146 offset1:147
    s_waitcnt lgkmcnt(9)
    v_mfma_f32_16x16x32_bf16 v[60:63], v[92:95], v[96:99], v[60:63]
    ds_read2_b32 v[92:93], v177 offset0:0 offset1:1
    ds_read2_b32 v[94:95], v177 offset0:2 offset1:3
    v_mfma_f32_16x16x32_bf16 v[56:59], v[88:91], v[96:99], v[56:59]
    s_lshl_b32 s61, s61, 6
    s_waitcnt lgkmcnt(10)
    v_mfma_f32_16x16x32_bf16 v[60:63], v[88:91], v[100:103], v[60:63]
    ds_read2_b32 v[88:89], v177 offset0:128 offset1:129
    ds_read2_b32 v[90:91], v177 offset0:130 offset1:131
    v_mfma_f32_16x16x32_bf16 v[52:55], v[84:87], v[96:99], v[52:55]
    v_add_u32 v12, s61, v22
    v_mfma_f32_16x16x32_bf16 v[56:59], v[84:87], v[100:103], v[56:59]
    s_add_u32 s61, s3, 3
    s_waitcnt lgkmcnt(11)
    v_mfma_f32_16x16x32_bf16 v[60:63], v[84:87], v[104:107], v[60:63]
    ds_read2_b32 v[84:85], v178 offset0:0 offset1:1
    ds_read2_b32 v[86:87], v178 offset0:2 offset1:3
    v_mfma_f32_16x16x32_bf16 v[48:51], v[80:83], v[96:99], v[48:51]
    s_and_b32 s61, s61, 3
    v_mfma_f32_16x16x32_bf16 v[52:55], v[80:83], v[100:103], v[52:55]
    s_lshl_b32 s61, s61, 6
    v_mfma_f32_16x16x32_bf16 v[56:59], v[80:83], v[104:107], v[56:59]
    v_add_u32 v13, s61, v22
    s_waitcnt lgkmcnt(12)
    v_mfma_f32_16x16x32_bf16 v[60:63], v[80:83], v[108:111], v[60:63]
    ds_read2_b32 v[80:81], v178 offset0:128 offset1:129
    ds_read2_b32 v[82:83], v178 offset0:130 offset1:131
    v_mfma_f32_16x16x32_bf16 v[44:47], v[76:79], v[96:99], v[44:47]
    v_mul_u32_u24 v20, 272, v18
    v_mfma_f32_16x16x32_bf16 v[48:51], v[76:79], v[100:103], v[48:51]
    v_lshl_add_u32 v20, v26, 5, v20
    v_mfma_f32_16x16x32_bf16 v[52:55], v[76:79], v[104:107], v[52:55]
    s_mul_i32 s61, s3, 4352
    v_mfma_f32_16x16x32_bf16 v[56:59], v[76:79], v[108:111], v[56:59]
    s_add_u32 s61, s61, 2176
    s_waitcnt lgkmcnt(13)
    v_mfma_f32_16x16x32_bf16 v[60:63], v[76:79], v[112:115], v[60:63]
    ds_read2_b32 v[76:77], v179 offset0:0 offset1:1
    ds_read2_b32 v[78:79], v179 offset0:2 offset1:3
    v_mfma_f32_16x16x32_bf16 v[40:43], v[72:75], v[96:99], v[40:43]
    v_add_u32 v20, s61, v20
    v_mfma_f32_16x16x32_bf16 v[44:47], v[72:75], v[100:103], v[44:47]
    v_add_u32 v21, 81920, v20
    v_mfma_f32_16x16x32_bf16 v[48:51], v[72:75], v[104:107], v[48:51]
    s_mul_i32 s73, s79, 172
    v_mfma_f32_16x16x32_bf16 v[52:55], v[72:75], v[108:111], v[52:55]
    s_mul_i32 s61, s3, 11
    v_mfma_f32_16x16x32_bf16 v[56:59], v[72:75], v[112:115], v[56:59]
    s_add_u32 s73, s73, s61
    s_waitcnt lgkmcnt(14)
    v_mfma_f32_16x16x32_bf16 v[60:63], v[72:75], v[116:119], v[60:63]
    ds_read2_b32 v[72:73], v179 offset0:128 offset1:129
    ds_read2_b32 v[74:75], v179 offset0:130 offset1:131
    v_mfma_f32_16x16x32_bf16 v[36:39], v[68:71], v[96:99], v[36:39]
    s_lshl_b32 s73, s73, 10
    v_mfma_f32_16x16x32_bf16 v[40:43], v[68:71], v[100:103], v[40:43]
    s_add_u32 s73, s73, 4201472
    v_mfma_f32_16x16x32_bf16 v[44:47], v[68:71], v[104:107], v[44:47]
    s_lshl_b32 s75, s79, 2
    v_mfma_f32_16x16x32_bf16 v[48:51], v[68:71], v[108:111], v[48:51]
    s_add_u32 s75, s75, s3
    v_mfma_f32_16x16x32_bf16 v[52:55], v[68:71], v[112:115], v[52:55]
    s_lshl_b32 s75, s75, 14
    v_mfma_f32_16x16x32_bf16 v[56:59], v[68:71], v[116:119], v[56:59]
    s_lshl_b32 s61, s80, 7
    s_waitcnt lgkmcnt(15)
    v_mfma_f32_16x16x32_bf16 v[60:63], v[68:71], v[120:123], v[60:63]
    ds_read2_b32 v[68:69], v180 offset0:0 offset1:1
    ds_read2_b32 v[70:71], v180 offset0:2 offset1:3
    s_waitcnt lgkmcnt(14)
    v_mfma_f32_16x16x32_bf16 v[32:35], v[64:67], v[96:99], v[32:35]
    ds_read_b128 v[96:99], v176 offset:20480
    v_mfma_f32_16x16x32_bf16 v[36:39], v[64:67], v[100:103], v[36:39]
    ds_read_b128 v[100:103], v176 offset:20992
    v_mfma_f32_16x16x32_bf16 v[40:43], v[64:67], v[104:107], v[40:43]
    ds_read_b128 v[104:107], v176 offset:21504
    v_mfma_f32_16x16x32_bf16 v[44:47], v[64:67], v[108:111], v[44:47]
    ds_read_b128 v[108:111], v176 offset:22016
    v_mfma_f32_16x16x32_bf16 v[48:51], v[64:67], v[112:115], v[48:51]
    ds_read_b128 v[112:115], v176 offset:22528
    v_mfma_f32_16x16x32_bf16 v[52:55], v[64:67], v[116:119], v[52:55]
    ds_read_b128 v[116:119], v176 offset:23040
    v_mfma_f32_16x16x32_bf16 v[56:59], v[64:67], v[120:123], v[56:59]
    ds_read_b128 v[120:123], v176 offset:23552
    v_mfma_f32_16x16x32_bf16 v[60:63], v[64:67], v[124:127], v[60:63]
    ds_read_b128 v[124:127], v176 offset:24064
    ds_read2_b32 v[64:65], v180 offset0:128 offset1:129
    ds_read2_b32 v[66:67], v180 offset0:130 offset1:131
    s_waitcnt lgkmcnt(9)
    v_mfma_f32_16x16x32_bf16 v[60:63], v[92:95], v[96:99], v[60:63]
    s_add_u32 s75, s75, s61
    v_mfma_f32_16x16x32_bf16 v[56:59], v[88:91], v[96:99], v[56:59]
    s_add_u32 s75, s75, 8192
    s_waitcnt lgkmcnt(8)
    v_mfma_f32_16x16x32_bf16 v[60:63], v[88:91], v[100:103], v[60:63]
    v_min_u32 v26, 5, v1
    v_mfma_f32_16x16x32_bf16 v[52:55], v[84:87], v[96:99], v[52:55]
    v_lshrrev_b32 v24, 1, v26
    v_mfma_f32_16x16x32_bf16 v[56:59], v[84:87], v[100:103], v[56:59]
    s_mul_i32 s61, s3, 15
    s_waitcnt lgkmcnt(7)
    v_mfma_f32_16x16x32_bf16 v[60:63], v[84:87], v[104:107], v[60:63]
    s_lshr_b32 s61, s61, 2
    v_mfma_f32_16x16x32_bf16 v[48:51], v[80:83], v[96:99], v[48:51]
    s_add_u32 s61, s61, 2
    v_mfma_f32_16x16x32_bf16 v[52:55], v[80:83], v[100:103], v[52:55]
    v_add_u32 v24, s61, v24
    v_mfma_f32_16x16x32_bf16 v[56:59], v[80:83], v[104:107], v[56:59]
    v_min_u32 v24, 14, v24
    s_waitcnt lgkmcnt(6)
    v_mfma_f32_16x16x32_bf16 v[60:63], v[80:83], v[108:111], v[60:63]
    v_and_b32 v26, 1, v26
    v_mfma_f32_16x16x32_bf16 v[44:47], v[76:79], v[96:99], v[44:47]
    v_lshlrev_b32 v24, 12, v24
    v_mfma_f32_16x16x32_bf16 v[48:51], v[76:79], v[100:103], v[48:51]
    v_lshl_add_u32 v24, v26, 3, v24
    v_mfma_f32_16x16x32_bf16 v[52:55], v[76:79], v[104:107], v[52:55]
    s_lshl_b32 s61, s79, 7
    v_mfma_f32_16x16x32_bf16 v[56:59], v[76:79], v[108:111], v[56:59]
    s_add_u32 s61, s61, 65536
    s_waitcnt lgkmcnt(5)
    v_mfma_f32_16x16x32_bf16 v[60:63], v[76:79], v[112:115], v[60:63]
    v_add_u32 v24, s61, v24
    v_mfma_f32_16x16x32_bf16 v[40:43], v[72:75], v[96:99], v[40:43]
    v_mfma_f32_16x16x32_bf16 v[44:47], v[72:75], v[100:103], v[44:47]
    v_mfma_f32_16x16x32_bf16 v[48:51], v[72:75], v[104:107], v[48:51]
    v_mfma_f32_16x16x32_bf16 v[52:55], v[72:75], v[108:111], v[52:55]
    v_mfma_f32_16x16x32_bf16 v[56:59], v[72:75], v[112:115], v[56:59]
    s_waitcnt lgkmcnt(4)
    v_mfma_f32_16x16x32_bf16 v[60:63], v[72:75], v[116:119], v[60:63]
    v_mfma_f32_16x16x32_bf16 v[36:39], v[68:71], v[96:99], v[36:39]
    ds_read_b64 v[140:141], v7 offset:20960
    v_mfma_f32_16x16x32_bf16 v[40:43], v[68:71], v[100:103], v[40:43]
    ds_read_b64 v[142:143], v7 offset:21472
    v_mfma_f32_16x16x32_bf16 v[44:47], v[68:71], v[104:107], v[44:47]
    ds_read_b64 v[144:145], v7 offset:21984
    v_mfma_f32_16x16x32_bf16 v[48:51], v[68:71], v[108:111], v[48:51]
    ds_read_b64 v[146:147], v7 offset:22496
    v_mfma_f32_16x16x32_bf16 v[52:55], v[68:71], v[112:115], v[52:55]
    v_mfma_f32_16x16x32_bf16 v[56:59], v[68:71], v[116:119], v[56:59]
    s_waitcnt lgkmcnt(7)
    v_mfma_f32_16x16x32_bf16 v[60:63], v[68:71], v[120:123], v[60:63]
    s_waitcnt lgkmcnt(4)
    v_mfma_f32_16x16x32_bf16 v[32:35], v[64:67], v[96:99], v[32:35]
    v_mfma_f32_16x16x32_bf16 v[36:39], v[64:67], v[100:103], v[36:39]
    v_mfma_f32_16x16x32_bf16 v[40:43], v[64:67], v[104:107], v[40:43]
    v_mfma_f32_16x16x32_bf16 v[44:47], v[64:67], v[108:111], v[44:47]
    v_mfma_f32_16x16x32_bf16 v[48:51], v[64:67], v[112:115], v[48:51]
    v_mfma_f32_16x16x32_bf16 v[52:55], v[64:67], v[116:119], v[52:55]
    v_mfma_f32_16x16x32_bf16 v[56:59], v[64:67], v[120:123], v[56:59]
    v_mfma_f32_16x16x32_bf16 v[60:63], v[64:67], v[124:127], v[60:63]
    s_cmp_eq_u32 s71, 0
    s_nop 7
    s_cbranch_scc1 L_sw_11
    v_swap_b32 v32, v48
    v_swap_b32 v33, v49
    v_swap_b32 v34, v50
    v_swap_b32 v35, v51
    v_swap_b32 v36, v52
    v_swap_b32 v37, v53
    v_swap_b32 v38, v54
    v_swap_b32 v39, v55
    v_swap_b32 v40, v56
    v_swap_b32 v41, v57
    v_swap_b32 v42, v58
    v_swap_b32 v43, v59
    v_swap_b32 v44, v60
    v_swap_b32 v45, v61
    v_swap_b32 v46, v62
    v_swap_b32 v47, v63
L_sw_11:
    ds_write_b128 v27, v[48:51] offset:30720
    ds_write_b128 v27, v[52:55] offset:31744
    ds_write_b128 v27, v[56:59] offset:32768
    ds_write_b128 v27, v[60:63] offset:33792
    s_add_u32 s72, s58, 2
    v_mov_b32 v170, s72
    v_mov_b32 v171, s56
    ds_write_b32 v171, v170 offset:40956
    buffer_load_dwordx2 v[22:23], v24, s[44:47], 0 offen sc1
    s_waitcnt lgkmcnt(5)
    v_lshlrev_b32 v64, 16, v140
    v_and_b32 v65, 0xffff0000, v140
    v_lshlrev_b32 v66, 16, v141
    v_and_b32 v67, 0xffff0000, v141
    v_lshlrev_b32 v68, 16, v142
    v_and_b32 v69, 0xffff0000, v142
    v_lshlrev_b32 v70, 16, v143
    v_and_b32 v71, 0xffff0000, v143
    v_lshlrev_b32 v72, 16, v144
    v_and_b32 v73, 0xffff0000, v144
    v_lshlrev_b32 v74, 16, v145
    v_and_b32 v75, 0xffff0000, v145
    v_lshlrev_b32 v76, 16, v146
    v_and_b32 v77, 0xffff0000, v146
    v_lshlrev_b32 v78, 16, v147
    v_and_b32 v79, 0xffff0000, v147
    v_fmac_f32 v32, v64, v181
    v_fmac_f32 v33, v65, v181
    v_fmac_f32 v34, v66, v181
    v_fmac_f32 v35, v67, v181
    v_fmac_f32 v36, v68, v181
    v_fmac_f32 v37, v69, v181
    v_fmac_f32 v38, v70, v181
    v_fmac_f32 v39, v71, v181
    v_fmac_f32 v40, v72, v181
    v_fmac_f32 v41, v73, v181
    v_fmac_f32 v42, v74, v181
    v_fmac_f32 v43, v75, v181
    v_fmac_f32 v44, v76, v181
    v_fmac_f32 v45, v77, v181
    v_fmac_f32 v46, v78, v181
    v_fmac_f32 v47, v79, v181
    s_add_u32 s72, s58, 2
    v_mov_b32 v172, s60
L_hs_12:
    ds_read_b32 v173, v172 offset:40956
    s_add_u32 s101, s101, 1
    s_waitcnt lgkmcnt(0)
    v_readfirstlane_b32 s33, v173
    s_cmp_lt_u32 s101, 4000000
    s_cselect_b32 s33, s33, s72
    s_cmp_lg_u32 s33, s72
    s_cbranch_scc1 L_hs_12
    ds_read_b128 v[64:67], v9 offset:30720
    ds_read_b128 v[68:71], v9 offset:31744
    ds_read_b128 v[72:75], v9 offset:32768
    ds_read_b128 v[76:79], v9 offset:33792
    s_waitcnt lgkmcnt(0)
    v_add_f32 v32, v32, v64
    v_add_f32 v33, v33, v65
    v_add_f32 v34, v34, v66
    v_add_f32 v35, v35, v67
    v_add_f32 v36, v36, v68
    v_add_f32 v37, v37, v69
    v_add_f32 v38, v38, v70
    v_add_f32 v39, v39, v71
    v_add_f32 v40, v40, v72
    v_add_f32 v41, v41, v73
    v_add_f32 v42, v42, v74
    v_add_f32 v43, v43, v75
    v_add_f32 v44, v44, v76
    v_add_f32 v45, v45, v77
    v_add_f32 v46, v46, v78
    v_add_f32 v47, v47, v79
    v_cvt_pk_bf16_f32 v148, v32, v33
    v_cvt_pk_bf16_f32 v149, v34, v35
    v_cvt_pk_bf16_f32 v152, v36, v37
    v_cvt_pk_bf16_f32 v153, v38, v39
    v_cvt_pk_bf16_f32 v156, v40, v41
    v_cvt_pk_bf16_f32 v157, v42, v43
    v_cvt_pk_bf16_f32 v160, v44, v45
    v_cvt_pk_bf16_f32 v161, v46, v47
    buffer_store_dwordx4 v[148:151], v8, s[44:47], s87 offen offset:0 sc1
    buffer_store_dwordx4 v[152:155], v8, s[44:47], s87 offen offset:1024 sc1
    buffer_store_dwordx4 v[156:159], v8, s[44:47], s87 offen offset:2048 sc1
    buffer_store_dwordx4 v[160:163], v8, s[44:47], s87 offen offset:3072 sc1
    s_add_u32 s72, s58, 6
    v_mov_b32 v170, s72
    v_mov_b32 v171, s56
    ds_write_b32 v171, v170 offset:40944
    s_setprio 0
    s_waitcnt vmcnt(4)
    v_cmp_ne_u64 vcc, s[58:59], v[22:23]
    s_cbranch_vccnz L_plp_14
L_pok_13:
    buffer_load_dwordx4 v[96:99], v2, s[44:47], s73 offen offset:0 sc1
    buffer_load_dwordx4 v[100:103], v3, s[44:47], s73 offen offset:0 sc1
    buffer_load_dwordx4 v[104:107], v4, s[44:47], s73 offen offset:0 sc1
    buffer_load_dwordx4 v[108:111], v5, s[44:47], s73 offen offset:0 sc1
    buffer_load_dwordx4 v[112:115], v2, s[44:47], s73 offen offset:1024 sc1
    buffer_load_dwordx4 v[116:119], v3, s[44:47], s73 offen offset:1024 sc1
    buffer_load_dwordx4 v[120:123], v4, s[44:47], s73 offen offset:1024 sc1
    buffer_load_dwordx4 v[124:127], v5, s[44:47], s73 offen offset:1024 sc1
    buffer_load_dwordx4 v[128:131], v2, s[44:47], s73 offen offset:2048 sc1
    buffer_load_dwordx4 v[132:135], v3, s[44:47], s73 offen offset:2048 sc1
    buffer_load_dwordx4 v[136:139], v4, s[44:47], s73 offen offset:2048 sc1
    buffer_load_dwordx4 v[140:143], v5, s[44:47], s73 offen offset:2048 sc1
    s_add_u32 s73, s73, s88
    buffer_load_dwordx4 v[144:147], v2, s[44:47], s73 offen offset:3072 sc1
    buffer_load_dwordx4 v[148:151], v3, s[44:47], s73 offen offset:3072 sc1
    buffer_load_dwordx4 v[152:155], v4, s[44:47], s73 offen offset:3072 sc1
    buffer_load_dwordx4 v[156:159], v5, s[44:47], s73 offen offset:3072 sc1
    s_add_u32 s72, s58, 6
    v_mov_b32 v172, s60
L_hs_15:
    ds_read_b32 v173, v172 offset:40944
    s_add_u32 s101, s101, 1
    s_waitcnt lgkmcnt(0)
    v_readfirstlane_b32 s33, v173
    s_cmp_lt_u32 s101, 4000000
    s_cselect_b32 s33, s33, s72
    s_cmp_lg_u32 s33, s72
    s_cbranch_scc1 L_hs_15
    s_waitcnt vmcnt(12)
    v_mfma_f32_16x16x32_bf16 v[32:35], v[192:195], v[96:99], 0
    buffer_load_dwordx4 v[164:167], v6, s[8:11], s75 offen
    v_mfma_f32_16x16x32_bf16 v[48:51], v[196:199], v[96:99], 0
    v_mfma_f32_16x16x32_bf16 v[64:67], v[200:203], v[96:99], 0
    v_mfma_f32_16x16x32_bf16 v[80:83], v[204:207], v[96:99], 0
    v_mfma_f32_16x16x32_bf16 v[36:39], v[192:195], v[100:103], 0
    v_mfma_f32_16x16x32_bf16 v[52:55], v[196:199], v[100:103], 0
    v_mfma_f32_16x16x32_bf16 v[68:71], v[200:203], v[100:103], 0
    v_mfma_f32_16x16x32_bf16 v[84:87], v[204:207], v[100:103], 0
    v_mfma_f32_16x16x32_bf16 v[40:43], v[192:195], v[104:107], 0
    v_mfma_f32_16x16x32_bf16 v[56:59], v[196:199], v[104:107], 0
    v_mfma_f32_16x16x32_bf16 v[72:75], v[200:203], v[104:107], 0
    v_mfma_f32_16x16x32_bf16 v[88:91], v[204:207], v[104:107], 0
    v_mfma_f32_16x16x32_bf16 v[44:47], v[192:195], v[108:111], 0
    v_mfma_f32_16x16x32_bf16 v[60:63], v[196:199], v[108:111], 0
    v_mfma_f32_16x16x32_bf16 v[76:79], v[200:203], v[108:111], 0
    v_mfma_f32_16x16x32_bf16 v[92:95], v[204:207], v[108:111], 0
    s_waitcnt vmcnt(9)
    s_add_u32 s72, s58, 7
    v_mov_b32 v170, s72
    v_mov_b32 v171, s56
    ds_write_b32 v171, v170 offset:40912
    v_mfma_f32_16x16x32_bf16 v[32:35], v[208:211], v[112:115], v[32:35]
    v_mfma_f32_16x16x32_bf16 v[48:51], v[212:215], v[112:115], v[48:51]
    v_mfma_f32_16x16x32_bf16 v[64:67], v[216:219], v[112:115], v[64:67]
    v_mfma_f32_16x16x32_bf16 v[80:83], v[220:223], v[112:115], v[80:83]
    v_mfma_f32_16x16x32_bf16 v[36:39], v[208:211], v[116:119], v[36:39]
    v_mfma_f32_16x16x32_bf16 v[52:55], v[212:215], v[116:119], v[52:55]
    v_mfma_f32_16x16x32_bf16 v[68:71], v[216:219], v[116:119], v[68:71]
    v_mfma_f32_16x16x32_bf16 v[84:87], v[220:223], v[116:119], v[84:87]
    v_mfma_f32_16x16x32_bf16 v[40:43], v[208:211], v[120:123], v[40:43]
    v_mfma_f32_16x16x32_bf16 v[56:59], v[212:215], v[120:123], v[56:59]
    v_mfma_f32_16x16x32_bf16 v[72:75], v[216:219], v[120:123], v[72:75]
    v_mfma_f32_16x16x32_bf16 v[88:91], v[220:223], v[120:123], v[88:91]
    v_mfma_f32_16x16x32_bf16 v[44:47], v[208:211], v[124:127], v[44:47]
    v_mfma_f32_16x16x32_bf16 v[60:63], v[212:215], v[124:127], v[60:63]
    v_mfma_f32_16x16x32_bf16 v[76:79], v[216:219], v[124:127], v[76:79]
    v_mfma_f32_16x16x32_bf16 v[92:95], v[220:223], v[124:127], v[92:95]
    s_waitcnt vmcnt(5)
    v_mfma_f32_16x16x32_bf16 v[32:35], v[224:227], v[128:131], v[32:35]
    s_waitcnt vmcnt(1)
    v_mfma_f32_16x16x32_bf16 v[32:35], v[240:243], v[144:147], v[32:35]
    v_mfma_f32_16x16x32_bf16 v[36:39], v[224:227], v[132:135], v[36:39]
    v_mfma_f32_16x16x32_bf16 v[36:39], v[240:243], v[148:151], v[36:39]
    v_mfma_f32_16x16x32_bf16 v[40:43], v[224:227], v[136:139], v[40:43]
    v_mfma_f32_16x16x32_bf16 v[40:43], v[240:243], v[152:155], v[40:43]
    v_mfma_f32_16x16x32_bf16 v[44:47], v[224:227], v[140:143], v[44:47]
    v_mfma_f32_16x16x32_bf16 v[44:47], v[240:243], v[156:159], v[44:47]
    v_mfma_f32_16x16x32_bf16 v[48:51], v[228:231], v[128:131], v[48:51]
    v_mfma_f32_16x16x32_bf16 v[48:51], v[244:247], v[144:147], v[48:51]
    ds_write_b128 v10, v[32:35] offset:20480
    v_mfma_f32_16x16x32_bf16 v[52:55], v[228:231], v[132:135], v[52:55]
    v_mfma_f32_16x16x32_bf16 v[52:55], v[244:247], v[148:151], v[52:55]
    ds_write_b128 v10, v[36:39] offset:24832
    v_mfma_f32_16x16x32_bf16 v[56:59], v[228:231], v[136:139], v[56:59]
    v_mfma_f32_16x16x32_bf16 v[56:59], v[244:247], v[152:155], v[56:59]
    ds_write_b128 v10, v[40:43] offset:29184
    v_mfma_f32_16x16x32_bf16 v[60:63], v[228:231], v[140:143], v[60:63]
    v_mfma_f32_16x16x32_bf16 v[60:63], v[244:247], v[156:159], v[60:63]
    ds_write_b128 v10, v[44:47] offset:33536
    v_mfma_f32_16x16x32_bf16 v[64:67], v[232:235], v[128:131], v[64:67]
    v_mfma_f32_16x16x32_bf16 v[64:67], v[248:251], v[144:147], v[64:67]
    ds_write_b128 v11, v[48:51] offset:20480
    v_mfma_f32_16x16x32_bf16 v[68:71], v[232:235], v[132:135], v[68:71]
    v_mfma_f32_16x16x32_bf16 v[68:71], v[248:251], v[148:151], v[68:71]
    ds_write_b128 v11, v[52:55] offset:24832
    v_mfma_f32_16x16x32_bf16 v[72:75], v[232:235], v[136:139], v[72:75]
    v_mfma_f32_16x16x32_bf16 v[72:75], v[248:251], v[152:155], v[72:75]
    ds_write_b128 v11, v[56:59] offset:29184
    v_mfma_f32_16x16x32_bf16 v[76:79], v[232:235], v[140:143], v[76:79]
    v_mfma_f32_16x16x32_bf16 v[76:79], v[248:251], v[156:159], v[76:79]
    ds_write_b128 v11, v[60:63] offset:33536
    v_mfma_f32_16x16x32_bf16 v[80:83], v[236:239], v[128:131], v[80:83]
    v_mfma_f32_16x16x32_bf16 v[80:83], v[252:255], v[144:147], v[80:83]
    ds_write_b128 v12, v[64:67] offset:20480
    v_mfma_f32_16x16x32_bf16 v[84:87], v[236:239], v[132:135], v[84:87]
    v_mfma_f32_16x16x32_bf16 v[84:87], v[252:255], v[148:151], v[84:87]
    ds_write_b128 v12, v[68:71] offset:24832
    v_mfma_f32_16x16x32_bf16 v[88:91], v[236:239], v[136:139], v[88:91]
    v_mfma_f32_16x16x32_bf16 v[88:91], v[252:255], v[152:155], v[88:91]
    ds_write_b128 v12, v[72:75] offset:29184
    v_mfma_f32_16x16x32_bf16 v[92:95], v[236:239], v[140:143], v[92:95]
    v_mfma_f32_16x16x32_bf16 v[92:95], v[252:255], v[156:159], v[92:95]
    ds_write_b128 v12, v[76:79] offset:33536
    ds_write_b128 v13, v[80:83] offset:20480
    ds_write_b128 v13, v[84:87] offset:24832
    s_nop 1
    ds_write_b128 v13, v[88:91] offset:29184
    s_nop 1
    ds_write_b128 v13, v[92:95] offset:33536
    s_waitcnt vmcnt(0)
    v_lshlrev_b32 v96, 16, v164
    v_and_b32 v97, 0xffff0000, v164
    v_lshlrev_b32 v98, 16, v165
    v_and_b32 v99, 0xffff0000, v165
    v_lshlrev_b32 v100, 16, v166
    v_and_b32 v101, 0xffff0000, v166
    v_lshlrev_b32 v102, 16, v167
    v_and_b32 v103, 0xffff0000, v167
    s_waitcnt lgkmcnt(0)
    s_barrier
    ds_read_b128 v[128:131], v20 offset:0
    ds_read_b128 v[132:135], v20 offset:16
    ds_read_b128 v[136:139], v20 offset:40960
    ds_read_b128 v[140:143], v20 offset:40976
    ds_read_b128 v[144:147], v21 offset:0
    ds_read_b128 v[148:151], v21 offset:16
    ds_read_b128 v[152:155], v21 offset:40960
    ds_read_b128 v[156:159], v21 offset:40976
    ds_read_b128 v[160:163], v20 offset:20480
    ds_read_b128 v[164:167], v20 offset:20496
    ds_read_b128 v[168:171], v20 offset:61440
    ds_read_b128 v[172:175], v20 offset:61456
    ds_read_b128 v[176:179], v21 offset:20480
    ds_read_b128 v[180:183], v21 offset:20496
    ds_read_b128 v[184:187], v21 offset:61440
    ds_read_b128 v[188:191], v21 offset:61456
    s_waitcnt lgkmcnt(12)
    v_pk_add_f32 v[128:129], v[128:129], v[136:137]
    v_pk_add_f32 v[130:131], v[130:131], v[138:139]
    v_pk_add_f32 v[132:133], v[132:133], v[140:141]
    v_pk_add_f32 v[134:135], v[134:135], v[142:143]
    v_pk_add_f32 v[96:97], v[96:97], v[128:129]
    v_pk_add_f32 v[98:99], v[98:99], v[130:131]
    v_pk_add_f32 v[100:101], v[100:101], v[132:133]
    v_pk_add_f32 v[102:103], v[102:103], v[134:135]
    s_waitcnt lgkmcnt(8)
    v_pk_add_f32 v[144:145], v[144:145], v[152:153]
    v_pk_add_f32 v[146:147], v[146:147], v[154:155]
    v_pk_add_f32 v[148:149], v[148:149], v[156:157]
    v_pk_add_f32 v[150:151], v[150:151], v[158:159]
    v_pk_add_f32 v[96:97], v[96:97], v[144:145]
    v_pk_add_f32 v[98:99], v[98:99], v[146:147]
    v_pk_add_f32 v[100:101], v[100:101], v[148:149]
    v_pk_add_f32 v[102:103], v[102:103], v[150:151]
    s_waitcnt lgkmcnt(4)
    v_pk_add_f32 v[160:161], v[160:161], v[168:169]
    v_pk_add_f32 v[162:163], v[162:163], v[170:171]
    v_pk_add_f32 v[164:165], v[164:165], v[172:173]
    v_pk_add_f32 v[166:167], v[166:167], v[174:175]
    v_pk_add_f32 v[96:97], v[96:97], v[160:161]
    v_pk_add_f32 v[98:99], v[98:99], v[162:163]
    v_pk_add_f32 v[100:101], v[100:101], v[164:165]
    v_pk_add_f32 v[102:103], v[102:103], v[166:167]
    s_waitcnt lgkmcnt(0)
    v_pk_add_f32 v[176:177], v[176:177], v[184:185]
    v_pk_add_f32 v[178:179], v[178:179], v[186:187]
    v_pk_add_f32 v[180:181], v[180:181], v[188:189]
    v_pk_add_f32 v[182:183], v[182:183], v[190:191]
    v_pk_add_f32 v[96:97], v[96:97], v[176:177]
    v_pk_add_f32 v[98:99], v[98:99], v[178:179]
    v_pk_add_f32 v[100:101], v[100:101], v[180:181]
    v_pk_add_f32 v[102:103], v[102:103], v[182:183]
    v_cvt_pk_bf16_f32 v112, v96, v97
    v_cvt_pk_bf16_f32 v113, v98, v99
    v_cvt_pk_bf16_f32 v114, v100, v101
    v_cvt_pk_bf16_f32 v115, v102, v103
    buffer_store_dwordx4 v[112:115], v6, s[52:55], s75 offen sc1
    s_endpgm
L_plp_2:
    s_sleep 4
    s_add_u32 s101, s101, 1
    s_cmp_gt_u32 s101, 4000000
    s_cbranch_scc1 L_pok_1
    buffer_load_dwordx2 v[22:23], v24, s[44:47], 0 offen sc1
    s_waitcnt vmcnt(0)
    v_cmp_ne_u64 vcc, s[58:59], v[22:23]
    s_cbranch_vccnz L_plp_2
    s_branch L_pok_1
L_alp_5:
    s_sleep 2
    s_add_u32 s101, s101, 1
    s_cmp_gt_u32 s101, 4000000
    s_cbranch_scc1 L_aok_4
    buffer_load_dwordx4 v[112:115], v7, s[44:47], s77 offen sc1
    buffer_load_dwordx4 v[116:119], v25, s[44:47], s77 offen sc1
    buffer_load_dwordx4 v[120:123], v7, s[44:47], s81 offen sc1
    buffer_load_dwordx4 v[124:127], v25, s[44:47], s81 offen sc1
    s_waitcnt vmcnt(0)
    v_cmp_ne_u64 vcc, s[58:59], v[114:115]
    v_cmp_ne_u64 s[62:63], s[58:59], v[118:119]
    s_nop 0
    s_or_b64 vcc, vcc, s[62:63]
    v_cmp_ne_u64 s[62:63], s[58:59], v[122:123]
    s_nop 0
    s_or_b64 vcc, vcc, s[62:63]
    v_cmp_ne_u64 s[62:63], s[58:59], v[126:127]
    s_nop 0
    s_or_b64 vcc, vcc, s[62:63]
    s_cbranch_vccnz L_alp_5
    s_branch L_aok_4
L_plp_7:
    s_sleep 8
    s_add_u32 s101, s101, 1
    s_cmp_gt_u32 s101, 4000000
    s_cbranch_scc1 L_pok_6
    buffer_load_dwordx2 v[188:189], v9, s[44:47], 0 offen sc1
    s_waitcnt vmcnt(0)
    v_cmp_ne_u64 vcc, s[58:59], v[188:189]
    s_cbranch_vccnz L_plp_7
    s_branch L_pok_6
L_plp_14:
    s_sleep 4
    s_add_u32 s101, s101, 1
    s_cmp_gt_u32 s101, 4000000
    s_cbranch_scc1 L_pok_13
    buffer_load_dwordx2 v[22:23], v24, s[44:47], 0 offen sc1
    s_waitcnt vmcnt(0)
    v_cmp_ne_u64 vcc, s[58:59], v[22:23]
    s_cbranch_vccnz L_plp_14
    s_branch L_pok_13
.fill (33024 - (. - parallel_sum__ssm_conv_s4d__geglu_ffn__prompt_kernel)) / 4, 4, 0xbf800000
.section .rodata,"a"
.p2align 6
.amdhsa_kernel parallel_sum__ssm_conv_s4d__geglu_ffn__prompt_kernel
  .amdhsa_next_free_vgpr 256
  .amdhsa_next_free_sgpr 102
  .amdhsa_accum_offset 256
  .amdhsa_group_segment_fixed_size 0
  .amdhsa_kernarg_size 112
  .amdhsa_user_sgpr_count 2
  .amdhsa_user_sgpr_kernarg_segment_ptr 1
  .amdhsa_system_sgpr_workgroup_id_x 1
.end_amdhsa_kernel
```
